```python
import torch

def _softmax(x, axis=-1):
    return torch.softmax(x, dim=axis)
def _gelu(x):
    return torch.nn.functional.gelu(x, approximate="tanh")
def _silu(x):
    return torch.nn.functional.silu(x)
def _sigmoid(x):
    return torch.sigmoid(x)
def _layernorm(x, axis=-1, eps=1e-5):
    m = x.mean(dim=axis, keepdim=True)
    v = x.var(dim=axis, keepdim=True, unbiased=False)
    return (x - m) / torch.sqrt(v + eps)
def _scatter_add(tgt, idx, src, axis=0):
    return tgt.clone().index_add_(axis, idx, src)
def _segment_sum(src, seg, n):
    out = torch.zeros((n,) + src.shape[1:], dtype=src.dtype)
    return out.index_add_(0, seg, src)
def _pad(x, pw):
    flat = tuple(v for pair in reversed(pw) for v in pair)
    return torch.nn.functional.pad(x, flat)

kernel_name = 'sequential_preLN__ssm_conv_s4d__glu_gated_geglu__prompt'

def setup_inputs():

    _w = (lambda a: (lambda t: t.to(torch.bfloat16) if t.is_floating_point() else t)(torch.as_tensor(a)))
    def _A_setup():
        Bsz, L, D, N = 1, 2048, 640, 128
        return {
            "u": _w((lambda *s: torch.randn(*s, dtype=torch.bfloat16) * 0.05)(Bsz, L, D)),
            "log_A_real": _w((lambda *s: torch.randn(*s, dtype=torch.bfloat16) * 6.4)(D, N) * 0.5),
            "A_imag": _w((lambda *s: torch.randn(*s, dtype=torch.bfloat16) * 0.05)(D, N) * 3.14),
            "C_real": _w((lambda *s: torch.randn(*s, dtype=torch.bfloat16) * 0.05)(D, N) / N ** 0.5),
            "C_imag": _w((lambda *s: torch.randn(*s, dtype=torch.bfloat16) * 0.05)(D, N) / N ** 0.5),
            "log_dt": _w((lambda *s: torch.randn(*s, dtype=torch.bfloat16) * 0.05)(D) * 0.5 - 4.0),
            "D_skip": _w((lambda *s: torch.randn(*s, dtype=torch.bfloat16) * 0.05)(D)),
        }
    _A_in = _A_setup()

    def _B_setup():
        B, S, Dm, Df = 1, 2048, 640, 1728
        return {
            "x": _w((lambda *s: torch.randn(*s, dtype=torch.bfloat16) * 0.05)(B, S, Dm)),
            "w_gate": _w((lambda *s: torch.randn(*s, dtype=torch.bfloat16) * 0.4)(Dm, Df) * (Dm ** -0.5)),
            "w_up": _w((lambda *s: torch.randn(*s, dtype=torch.bfloat16) * 0.4)(Dm, Df) * (Dm ** -0.5)),
            "w_down": _w((lambda *s: torch.randn(*s, dtype=torch.bfloat16) * 0.4)(Df, Dm) * (Df ** -0.5)),
        }
    _B_in = _B_setup()

    return {
        "A_u": _A_in["u"],
        "A_log_A_real": _A_in["log_A_real"],
        "A_A_imag": _A_in["A_imag"],
        "A_C_real": _A_in["C_real"],
        "A_C_imag": _A_in["C_imag"],
        "A_log_dt": _A_in["log_dt"],
        "A_D_skip": _A_in["D_skip"],
        "B_x": _B_in["x"],
        "B_w_gate": _B_in["w_gate"],
        "B_w_up": _B_in["w_up"],
        "B_w_down": _B_in["w_down"],
    }

def reference(A_u, A_log_A_real, A_A_imag, A_C_real, A_C_imag, A_log_dt, A_D_skip, B_x, B_w_gate, B_w_up, B_w_down):
    def _A_ref(u, log_A_real, A_imag, C_real, C_imag, log_dt, D_skip):
        L = u.shape[1]
        dt = torch.exp(log_dt)
        A = -torch.exp(log_A_real) + 1j * A_imag
        C = (C_real + 1j * C_imag) * dt[:, None]
        pos = (lambda x, dt: x.to(dt))(torch.arange(L), log_dt.dtype)
        P = torch.exp((A * dt[:, None])[:, :, None] * pos[None, None, :])
        K = 2.0 * torch.einsum("dn,dnl->dl", C, P).real
        L2 = 2 * L
        u_t = (lambda x, *d: x.permute(*d))(u, 0, 2, 1)
        Kf = (lambda x, *a, **k: torch.fft.rfft(x.float(), *a, **k))(K, L2)
        Uf = (lambda x, *a, **k: torch.fft.rfft(x.float(), *a, **k))(u_t, L2)
        y = (lambda x, *a, **k: torch.fft.irfft(x, *a, **k).to(torch.bfloat16))(Uf * Kf[None, :, :], L2)[:, :, :L]
        y = (lambda x, *d: x.permute(*d))(y, 0, 2, 1)
        return y + u * D_skip[None, None, :]

    def _B_ref(x, w_gate, w_up, w_down):
        g = torch.einsum("bsd,df->bsf", x, w_gate)
        u = torch.einsum("bsd,df->bsf", x, w_up)
        h = _gelu(g) * u
        return torch.einsum("bsf,fd->bsd", h, w_down)

    x = A_u
    h = x + _A_ref(_layernorm(x, axis=-1), A_log_A_real, A_A_imag, A_C_real, A_C_imag, A_log_dt, A_D_skip)
    h2 = h + _B_ref(_layernorm(h, axis=-1), B_w_gate, B_w_up, B_w_down)
    return h2
```

```asm
; @launch kernel=ln1_kernel grid=(972,1,1) block=(256,1,1) lds=29952
; @launch kernel=conv_kernel grid=(640,1,1) block=(256,1,1) lds=43008
; @launch kernel=ln2_kernel grid=(256,1,1) block=(256,1,1) lds=0
; @launch kernel=gemm1_kernel grid=(216,1,1) block=(512,1,1) lds=147456
; @launch kernel=gemm2_kernel grid=(160,1,1) block=(512,1,1) lds=122880
.amdgcn_target "amdgcn-amd-amdhsa--gfx950"
.text
.globl ln1_kernel
.p2align 8
.type ln1_kernel,@function
ln1_kernel:
    s_cmp_ge_u32 s2, 972
    s_cbranch_scc1 ln1_end
    s_cmp_lt_u32 s2, 640
    s_cbranch_scc1 kg_start
    s_sub_u32 s2, s2, 640
    s_cmp_ge_u32 s2, 128
    s_cbranch_scc1 wt_start
    s_load_dwordx2 s[4:5], s[0:1], 0
    s_load_dwordx2 s[6:7], s[0:1], 104
    s_waitcnt lgkmcnt(0)
    s_mov_b32 s8, s4
    s_mov_b32 s9, s5
    s_mov_b32 s10, 2621440
    s_mov_b32 s11, 0x00020000
    s_mov_b32 s12, s6
    s_mov_b32 s13, s7
    s_mov_b32 s14, 67108864
    s_mov_b32 s15, 0x00020000
    v_and_b32 v1, 63, v0
    v_lshrrev_b32 v2, 6, v0
    v_xor_b32 v4, 1, v1
    v_lshlrev_b32 v4, 2, v4
    v_xor_b32 v5, 2, v1
    v_lshlrev_b32 v5, 2, v5
    v_xor_b32 v6, 4, v1
    v_lshlrev_b32 v6, 2, v6
    v_xor_b32 v7, 8, v1
    v_lshlrev_b32 v7, 2, v7
    v_xor_b32 v8, 16, v1
    v_lshlrev_b32 v8, 2, v8
    v_xor_b32 v9, 32, v1
    v_lshlrev_b32 v9, 2, v9
    s_mul_i32 s16, s2, 20480
    v_mul_u32_u24 v3, 5120, v2
    v_lshl_add_u32 v3, v1, 2, v3
    s_add_u32 s17, s16, 0
    buffer_load_dword v16, v3, s[8:11], s17 offen offset:0
    buffer_load_dword v17, v3, s[8:11], s17 offen offset:256
    buffer_load_dword v18, v3, s[8:11], s17 offen offset:512
    buffer_load_dword v19, v3, s[8:11], s17 offen offset:768
    buffer_load_dword v20, v3, s[8:11], s17 offen offset:1024
    s_add_u32 s17, s16, 1280
    buffer_load_dword v21, v3, s[8:11], s17 offen offset:0
    buffer_load_dword v22, v3, s[8:11], s17 offen offset:256
    buffer_load_dword v23, v3, s[8:11], s17 offen offset:512
    buffer_load_dword v24, v3, s[8:11], s17 offen offset:768
    buffer_load_dword v25, v3, s[8:11], s17 offen offset:1024
    s_add_u32 s17, s16, 2560
    buffer_load_dword v26, v3, s[8:11], s17 offen offset:0
    buffer_load_dword v27, v3, s[8:11], s17 offen offset:256
    buffer_load_dword v28, v3, s[8:11], s17 offen offset:512
    buffer_load_dword v29, v3, s[8:11], s17 offen offset:768
    buffer_load_dword v30, v3, s[8:11], s17 offen offset:1024
    s_add_u32 s17, s16, 3840
    buffer_load_dword v31, v3, s[8:11], s17 offen offset:0
    buffer_load_dword v32, v3, s[8:11], s17 offen offset:256
    buffer_load_dword v33, v3, s[8:11], s17 offen offset:512
    buffer_load_dword v34, v3, s[8:11], s17 offen offset:768
    buffer_load_dword v35, v3, s[8:11], s17 offen offset:1024
    s_mov_b32 s20, 0x05040100
    s_mov_b32 s21, 0x07060302
    s_waitcnt vmcnt(0)
    v_mov_b32 v56, 0
    v_lshlrev_b32 v72, 16, v16
    v_and_b32 v73, 0xffff0000, v16
    v_add_f32 v56, v56, v72
    v_add_f32 v56, v56, v73
    v_lshlrev_b32 v72, 16, v17
    v_and_b32 v73, 0xffff0000, v17
    v_add_f32 v56, v56, v72
    v_add_f32 v56, v56, v73
    v_lshlrev_b32 v72, 16, v18
    v_and_b32 v73, 0xffff0000, v18
    v_add_f32 v56, v56, v72
    v_add_f32 v56, v56, v73
    v_lshlrev_b32 v72, 16, v19
    v_and_b32 v73, 0xffff0000, v19
    v_add_f32 v56, v56, v72
    v_add_f32 v56, v56, v73
    v_lshlrev_b32 v72, 16, v20
    v_and_b32 v73, 0xffff0000, v20
    v_add_f32 v56, v56, v72
    v_add_f32 v56, v56, v73
    v_mov_b32 v57, 0
    v_lshlrev_b32 v72, 16, v21
    v_and_b32 v73, 0xffff0000, v21
    v_add_f32 v57, v57, v72
    v_add_f32 v57, v57, v73
    v_lshlrev_b32 v72, 16, v22
    v_and_b32 v73, 0xffff0000, v22
    v_add_f32 v57, v57, v72
    v_add_f32 v57, v57, v73
    v_lshlrev_b32 v72, 16, v23
    v_and_b32 v73, 0xffff0000, v23
    v_add_f32 v57, v57, v72
    v_add_f32 v57, v57, v73
    v_lshlrev_b32 v72, 16, v24
    v_and_b32 v73, 0xffff0000, v24
    v_add_f32 v57, v57, v72
    v_add_f32 v57, v57, v73
    v_lshlrev_b32 v72, 16, v25
    v_and_b32 v73, 0xffff0000, v25
    v_add_f32 v57, v57, v72
    v_add_f32 v57, v57, v73
    v_mov_b32 v58, 0
    v_lshlrev_b32 v72, 16, v26
    v_and_b32 v73, 0xffff0000, v26
    v_add_f32 v58, v58, v72
    v_add_f32 v58, v58, v73
    v_lshlrev_b32 v72, 16, v27
    v_and_b32 v73, 0xffff0000, v27
    v_add_f32 v58, v58, v72
    v_add_f32 v58, v58, v73
    v_lshlrev_b32 v72, 16, v28
    v_and_b32 v73, 0xffff0000, v28
    v_add_f32 v58, v58, v72
    v_add_f32 v58, v58, v73
    v_lshlrev_b32 v72, 16, v29
    v_and_b32 v73, 0xffff0000, v29
    v_add_f32 v58, v58, v72
    v_add_f32 v58, v58, v73
    v_lshlrev_b32 v72, 16, v30
    v_and_b32 v73, 0xffff0000, v30
    v_add_f32 v58, v58, v72
    v_add_f32 v58, v58, v73
    v_mov_b32 v59, 0
    v_lshlrev_b32 v72, 16, v31
    v_and_b32 v73, 0xffff0000, v31
    v_add_f32 v59, v59, v72
    v_add_f32 v59, v59, v73
    v_lshlrev_b32 v72, 16, v32
    v_and_b32 v73, 0xffff0000, v32
    v_add_f32 v59, v59, v72
    v_add_f32 v59, v59, v73
    v_lshlrev_b32 v72, 16, v33
    v_and_b32 v73, 0xffff0000, v33
    v_add_f32 v59, v59, v72
    v_add_f32 v59, v59, v73
    v_lshlrev_b32 v72, 16, v34
    v_and_b32 v73, 0xffff0000, v34
    v_add_f32 v59, v59, v72
    v_add_f32 v59, v59, v73
    v_lshlrev_b32 v72, 16, v35
    v_and_b32 v73, 0xffff0000, v35
    v_add_f32 v59, v59, v72
    v_add_f32 v59, v59, v73
    s_nop 1
    v_add_f32_dpp v56, v56, v56 row_shr:1 row_mask:0xf bank_mask:0xf bound_ctrl:0
    v_add_f32_dpp v57, v57, v57 row_shr:1 row_mask:0xf bank_mask:0xf bound_ctrl:0
    v_add_f32_dpp v58, v58, v58 row_shr:1 row_mask:0xf bank_mask:0xf bound_ctrl:0
    v_add_f32_dpp v59, v59, v59 row_shr:1 row_mask:0xf bank_mask:0xf bound_ctrl:0
    s_nop 1
    v_add_f32_dpp v56, v56, v56 row_shr:2 row_mask:0xf bank_mask:0xf bound_ctrl:0
    v_add_f32_dpp v57, v57, v57 row_shr:2 row_mask:0xf bank_mask:0xf bound_ctrl:0
    v_add_f32_dpp v58, v58, v58 row_shr:2 row_mask:0xf bank_mask:0xf bound_ctrl:0
    v_add_f32_dpp v59, v59, v59 row_shr:2 row_mask:0xf bank_mask:0xf bound_ctrl:0
    s_nop 1
    v_add_f32_dpp v56, v56, v56 row_shr:4 row_mask:0xf bank_mask:0xf bound_ctrl:0
    v_add_f32_dpp v57, v57, v57 row_shr:4 row_mask:0xf bank_mask:0xf bound_ctrl:0
    v_add_f32_dpp v58, v58, v58 row_shr:4 row_mask:0xf bank_mask:0xf bound_ctrl:0
    v_add_f32_dpp v59, v59, v59 row_shr:4 row_mask:0xf bank_mask:0xf bound_ctrl:0
    s_nop 1
    v_add_f32_dpp v56, v56, v56 row_shr:8 row_mask:0xf bank_mask:0xf bound_ctrl:0
    v_add_f32_dpp v57, v57, v57 row_shr:8 row_mask:0xf bank_mask:0xf bound_ctrl:0
    v_add_f32_dpp v58, v58, v58 row_shr:8 row_mask:0xf bank_mask:0xf bound_ctrl:0
    v_add_f32_dpp v59, v59, v59 row_shr:8 row_mask:0xf bank_mask:0xf bound_ctrl:0
    s_nop 1
    v_add_f32_dpp v56, v56, v56 row_bcast:15 row_mask:0xa bank_mask:0xf
    v_add_f32_dpp v57, v57, v57 row_bcast:15 row_mask:0xa bank_mask:0xf
    v_add_f32_dpp v58, v58, v58 row_bcast:15 row_mask:0xa bank_mask:0xf
    v_add_f32_dpp v59, v59, v59 row_bcast:15 row_mask:0xa bank_mask:0xf
    s_nop 1
    v_add_f32_dpp v56, v56, v56 row_bcast:31 row_mask:0xc bank_mask:0xf
    v_add_f32_dpp v57, v57, v57 row_bcast:31 row_mask:0xc bank_mask:0xf
    v_add_f32_dpp v58, v58, v58 row_bcast:31 row_mask:0xc bank_mask:0xf
    v_add_f32_dpp v59, v59, v59 row_bcast:31 row_mask:0xc bank_mask:0xf
    s_nop 1
    v_readlane_b32 s70, v56, 63
    v_readlane_b32 s71, v57, 63
    v_readlane_b32 s72, v58, 63
    v_readlane_b32 s73, v59, 63
    s_nop 1
    v_mov_b32 v56, s70
    v_mov_b32 v57, s71
    v_mov_b32 v58, s72
    v_mov_b32 v59, s73
    v_mul_f32 v76, 0x3acccccd, v56
    v_mov_b32 v56, 0
    v_lshlrev_b32 v72, 16, v16
    v_and_b32 v73, 0xffff0000, v16
    v_sub_f32 v72, v72, v76
    v_sub_f32 v73, v73, v76
    v_fmac_f32 v56, v72, v72
    v_fmac_f32 v56, v73, v73
    v_lshlrev_b32 v72, 16, v17
    v_and_b32 v73, 0xffff0000, v17
    v_sub_f32 v72, v72, v76
    v_sub_f32 v73, v73, v76
    v_fmac_f32 v56, v72, v72
    v_fmac_f32 v56, v73, v73
    v_lshlrev_b32 v72, 16, v18
    v_and_b32 v73, 0xffff0000, v18
    v_sub_f32 v72, v72, v76
    v_sub_f32 v73, v73, v76
    v_fmac_f32 v56, v72, v72
    v_fmac_f32 v56, v73, v73
    v_lshlrev_b32 v72, 16, v19
    v_and_b32 v73, 0xffff0000, v19
    v_sub_f32 v72, v72, v76
    v_sub_f32 v73, v73, v76
    v_fmac_f32 v56, v72, v72
    v_fmac_f32 v56, v73, v73
    v_lshlrev_b32 v72, 16, v20
    v_and_b32 v73, 0xffff0000, v20
    v_sub_f32 v72, v72, v76
    v_sub_f32 v73, v73, v76
    v_fmac_f32 v56, v72, v72
    v_fmac_f32 v56, v73, v73
    v_mul_f32 v77, 0x3acccccd, v57
    v_mov_b32 v57, 0
    v_lshlrev_b32 v72, 16, v21
    v_and_b32 v73, 0xffff0000, v21
    v_sub_f32 v72, v72, v77
    v_sub_f32 v73, v73, v77
    v_fmac_f32 v57, v72, v72
    v_fmac_f32 v57, v73, v73
    v_lshlrev_b32 v72, 16, v22
    v_and_b32 v73, 0xffff0000, v22
    v_sub_f32 v72, v72, v77
    v_sub_f32 v73, v73, v77
    v_fmac_f32 v57, v72, v72
    v_fmac_f32 v57, v73, v73
    v_lshlrev_b32 v72, 16, v23
    v_and_b32 v73, 0xffff0000, v23
    v_sub_f32 v72, v72, v77
    v_sub_f32 v73, v73, v77
    v_fmac_f32 v57, v72, v72
    v_fmac_f32 v57, v73, v73
    v_lshlrev_b32 v72, 16, v24
    v_and_b32 v73, 0xffff0000, v24
    v_sub_f32 v72, v72, v77
    v_sub_f32 v73, v73, v77
    v_fmac_f32 v57, v72, v72
    v_fmac_f32 v57, v73, v73
    v_lshlrev_b32 v72, 16, v25
    v_and_b32 v73, 0xffff0000, v25
    v_sub_f32 v72, v72, v77
    v_sub_f32 v73, v73, v77
    v_fmac_f32 v57, v72, v72
    v_fmac_f32 v57, v73, v73
    v_mul_f32 v78, 0x3acccccd, v58
    v_mov_b32 v58, 0
    v_lshlrev_b32 v72, 16, v26
    v_and_b32 v73, 0xffff0000, v26
    v_sub_f32 v72, v72, v78
    v_sub_f32 v73, v73, v78
    v_fmac_f32 v58, v72, v72
    v_fmac_f32 v58, v73, v73
    v_lshlrev_b32 v72, 16, v27
    v_and_b32 v73, 0xffff0000, v27
    v_sub_f32 v72, v72, v78
    v_sub_f32 v73, v73, v78
    v_fmac_f32 v58, v72, v72
    v_fmac_f32 v58, v73, v73
    v_lshlrev_b32 v72, 16, v28
    v_and_b32 v73, 0xffff0000, v28
    v_sub_f32 v72, v72, v78
    v_sub_f32 v73, v73, v78
    v_fmac_f32 v58, v72, v72
    v_fmac_f32 v58, v73, v73
    v_lshlrev_b32 v72, 16, v29
    v_and_b32 v73, 0xffff0000, v29
    v_sub_f32 v72, v72, v78
    v_sub_f32 v73, v73, v78
    v_fmac_f32 v58, v72, v72
    v_fmac_f32 v58, v73, v73
    v_lshlrev_b32 v72, 16, v30
    v_and_b32 v73, 0xffff0000, v30
    v_sub_f32 v72, v72, v78
    v_sub_f32 v73, v73, v78
    v_fmac_f32 v58, v72, v72
    v_fmac_f32 v58, v73, v73
    v_mul_f32 v79, 0x3acccccd, v59
    v_mov_b32 v59, 0
    v_lshlrev_b32 v72, 16, v31
    v_and_b32 v73, 0xffff0000, v31
    v_sub_f32 v72, v72, v79
    v_sub_f32 v73, v73, v79
    v_fmac_f32 v59, v72, v72
    v_fmac_f32 v59, v73, v73
    v_lshlrev_b32 v72, 16, v32
    v_and_b32 v73, 0xffff0000, v32
    v_sub_f32 v72, v72, v79
    v_sub_f32 v73, v73, v79
    v_fmac_f32 v59, v72, v72
    v_fmac_f32 v59, v73, v73
    v_lshlrev_b32 v72, 16, v33
    v_and_b32 v73, 0xffff0000, v33
    v_sub_f32 v72, v72, v79
    v_sub_f32 v73, v73, v79
    v_fmac_f32 v59, v72, v72
    v_fmac_f32 v59, v73, v73
    v_lshlrev_b32 v72, 16, v34
    v_and_b32 v73, 0xffff0000, v34
    v_sub_f32 v72, v72, v79
    v_sub_f32 v73, v73, v79
    v_fmac_f32 v59, v72, v72
    v_fmac_f32 v59, v73, v73
    v_lshlrev_b32 v72, 16, v35
    v_and_b32 v73, 0xffff0000, v35
    v_sub_f32 v72, v72, v79
    v_sub_f32 v73, v73, v79
    v_fmac_f32 v59, v72, v72
    v_fmac_f32 v59, v73, v73
    s_nop 1
    v_add_f32_dpp v56, v56, v56 row_shr:1 row_mask:0xf bank_mask:0xf bound_ctrl:0
    v_add_f32_dpp v57, v57, v57 row_shr:1 row_mask:0xf bank_mask:0xf bound_ctrl:0
    v_add_f32_dpp v58, v58, v58 row_shr:1 row_mask:0xf bank_mask:0xf bound_ctrl:0
    v_add_f32_dpp v59, v59, v59 row_shr:1 row_mask:0xf bank_mask:0xf bound_ctrl:0
    s_nop 1
    v_add_f32_dpp v56, v56, v56 row_shr:2 row_mask:0xf bank_mask:0xf bound_ctrl:0
    v_add_f32_dpp v57, v57, v57 row_shr:2 row_mask:0xf bank_mask:0xf bound_ctrl:0
    v_add_f32_dpp v58, v58, v58 row_shr:2 row_mask:0xf bank_mask:0xf bound_ctrl:0
    v_add_f32_dpp v59, v59, v59 row_shr:2 row_mask:0xf bank_mask:0xf bound_ctrl:0
    s_nop 1
    v_add_f32_dpp v56, v56, v56 row_shr:4 row_mask:0xf bank_mask:0xf bound_ctrl:0
    v_add_f32_dpp v57, v57, v57 row_shr:4 row_mask:0xf bank_mask:0xf bound_ctrl:0
    v_add_f32_dpp v58, v58, v58 row_shr:4 row_mask:0xf bank_mask:0xf bound_ctrl:0
    v_add_f32_dpp v59, v59, v59 row_shr:4 row_mask:0xf bank_mask:0xf bound_ctrl:0
    s_nop 1
    v_add_f32_dpp v56, v56, v56 row_shr:8 row_mask:0xf bank_mask:0xf bound_ctrl:0
    v_add_f32_dpp v57, v57, v57 row_shr:8 row_mask:0xf bank_mask:0xf bound_ctrl:0
    v_add_f32_dpp v58, v58, v58 row_shr:8 row_mask:0xf bank_mask:0xf bound_ctrl:0
    v_add_f32_dpp v59, v59, v59 row_shr:8 row_mask:0xf bank_mask:0xf bound_ctrl:0
    s_nop 1
    v_add_f32_dpp v56, v56, v56 row_bcast:15 row_mask:0xa bank_mask:0xf
    v_add_f32_dpp v57, v57, v57 row_bcast:15 row_mask:0xa bank_mask:0xf
    v_add_f32_dpp v58, v58, v58 row_bcast:15 row_mask:0xa bank_mask:0xf
    v_add_f32_dpp v59, v59, v59 row_bcast:15 row_mask:0xa bank_mask:0xf
    s_nop 1
    v_add_f32_dpp v56, v56, v56 row_bcast:31 row_mask:0xc bank_mask:0xf
    v_add_f32_dpp v57, v57, v57 row_bcast:31 row_mask:0xc bank_mask:0xf
    v_add_f32_dpp v58, v58, v58 row_bcast:31 row_mask:0xc bank_mask:0xf
    v_add_f32_dpp v59, v59, v59 row_bcast:31 row_mask:0xc bank_mask:0xf
    s_nop 1
    v_readlane_b32 s70, v56, 63
    v_readlane_b32 s71, v57, 63
    v_readlane_b32 s72, v58, 63
    v_readlane_b32 s73, v59, 63
    s_nop 1
    v_mov_b32 v56, s70
    v_mov_b32 v57, s71
    v_mov_b32 v58, s72
    v_mov_b32 v59, s73
    v_mul_f32 v72, 0x3acccccd, v56
    v_cvt_pk_bf16_f32 v72, v72, v72
    v_lshlrev_b32 v72, 16, v72
    v_add_f32 v72, 0x3727c5ac, v72
    v_cvt_pk_bf16_f32 v72, v72, v72
    v_lshlrev_b32 v72, 16, v72
    v_sqrt_f32 v72, v72
    s_nop 0
    v_cvt_pk_bf16_f32 v84, v72, v72
    v_lshlrev_b32 v84, 16, v84
    v_rcp_f32 v92, v84
    v_cvt_pk_bf16_f32 v76, v76, v76
    v_lshlrev_b32 v76, 16, v76
    v_mul_f32 v72, 0x3acccccd, v57
    v_cvt_pk_bf16_f32 v72, v72, v72
    v_lshlrev_b32 v72, 16, v72
    v_add_f32 v72, 0x3727c5ac, v72
    v_cvt_pk_bf16_f32 v72, v72, v72
    v_lshlrev_b32 v72, 16, v72
    v_sqrt_f32 v72, v72
    s_nop 0
    v_cvt_pk_bf16_f32 v85, v72, v72
    v_lshlrev_b32 v85, 16, v85
    v_rcp_f32 v93, v85
    v_cvt_pk_bf16_f32 v77, v77, v77
    v_lshlrev_b32 v77, 16, v77
    v_mul_f32 v72, 0x3acccccd, v58
    v_cvt_pk_bf16_f32 v72, v72, v72
    v_lshlrev_b32 v72, 16, v72
    v_add_f32 v72, 0x3727c5ac, v72
    v_cvt_pk_bf16_f32 v72, v72, v72
    v_lshlrev_b32 v72, 16, v72
    v_sqrt_f32 v72, v72
    s_nop 0
    v_cvt_pk_bf16_f32 v86, v72, v72
    v_lshlrev_b32 v86, 16, v86
    v_rcp_f32 v94, v86
    v_cvt_pk_bf16_f32 v78, v78, v78
    v_lshlrev_b32 v78, 16, v78
    v_mul_f32 v72, 0x3acccccd, v59
    v_cvt_pk_bf16_f32 v72, v72, v72
    v_lshlrev_b32 v72, 16, v72
    v_add_f32 v72, 0x3727c5ac, v72
    v_cvt_pk_bf16_f32 v72, v72, v72
    v_lshlrev_b32 v72, 16, v72
    v_sqrt_f32 v72, v72
    s_nop 0
    v_cvt_pk_bf16_f32 v87, v72, v72
    v_lshlrev_b32 v87, 16, v87
    v_rcp_f32 v95, v87
    v_cvt_pk_bf16_f32 v79, v79, v79
    v_lshlrev_b32 v79, 16, v79
    v_lshlrev_b32 v10, 7, v1
    v_lshl_add_u32 v10, v2, 3, v10
    s_lshr_b32 s17, s2, 1
    s_mul_i32 s17, s17, 40960
    s_and_b32 s18, s2, 1
    s_lshl_b32 s18, s18, 5
    s_add_u32 s17, s17, s18
    v_lshlrev_b32 v72, 16, v16
    v_and_b32 v73, 0xffff0000, v16
    v_sub_f32 v72, v72, v76
    v_sub_f32 v73, v73, v76
    v_cvt_pk_bf16_f32 v74, v72, v73
    v_lshlrev_b32 v72, 16, v74
    v_and_b32 v73, 0xffff0000, v74
    v_mul_f32 v74, v72, v92
    v_fma_f32 v75, -v74, v84, v72
    v_fma_f32 v72, v75, v92, v74
    v_mul_f32 v74, v73, v92
    v_fma_f32 v75, -v74, v84, v73
    v_fma_f32 v73, v75, v92, v74
    v_cvt_pk_bf16_f32 v104, v72, v73
    v_lshlrev_b32 v72, 16, v21
    v_and_b32 v73, 0xffff0000, v21
    v_sub_f32 v72, v72, v77
    v_sub_f32 v73, v73, v77
    v_cvt_pk_bf16_f32 v74, v72, v73
    v_lshlrev_b32 v72, 16, v74
    v_and_b32 v73, 0xffff0000, v74
    v_mul_f32 v74, v72, v93
    v_fma_f32 v75, -v74, v85, v72
    v_fma_f32 v72, v75, v93, v74
    v_mul_f32 v74, v73, v93
    v_fma_f32 v75, -v74, v85, v73
    v_fma_f32 v73, v75, v93, v74
    v_cvt_pk_bf16_f32 v105, v72, v73
    v_lshlrev_b32 v72, 16, v26
    v_and_b32 v73, 0xffff0000, v26
    v_sub_f32 v72, v72, v78
    v_sub_f32 v73, v73, v78
    v_cvt_pk_bf16_f32 v74, v72, v73
    v_lshlrev_b32 v72, 16, v74
    v_and_b32 v73, 0xffff0000, v74
    v_mul_f32 v74, v72, v94
    v_fma_f32 v75, -v74, v86, v72
    v_fma_f32 v72, v75, v94, v74
    v_mul_f32 v74, v73, v94
    v_fma_f32 v75, -v74, v86, v73
    v_fma_f32 v73, v75, v94, v74
    v_cvt_pk_bf16_f32 v106, v72, v73
    v_lshlrev_b32 v72, 16, v31
    v_and_b32 v73, 0xffff0000, v31
    v_sub_f32 v72, v72, v79
    v_sub_f32 v73, v73, v79
    v_cvt_pk_bf16_f32 v74, v72, v73
    v_lshlrev_b32 v72, 16, v74
    v_and_b32 v73, 0xffff0000, v74
    v_mul_f32 v74, v72, v95
    v_fma_f32 v75, -v74, v87, v72
    v_fma_f32 v72, v75, v95, v74
    v_mul_f32 v74, v73, v95
    v_fma_f32 v75, -v74, v87, v73
    v_fma_f32 v73, v75, v95, v74
    v_cvt_pk_bf16_f32 v107, v72, v73
    v_perm_b32 v112, v105, v104, s20
    v_perm_b32 v116, v105, v104, s21
    v_perm_b32 v113, v107, v106, s20
    v_perm_b32 v117, v107, v106, s21
    buffer_store_dwordx2 v[112:113], v10, s[12:15], s17 offen
    buffer_store_dwordx2 v[116:117], v10, s[12:15], s17 offen offset:64
    s_add_u32 s17, s17, 8192
    s_nop 1
    v_lshlrev_b32 v72, 16, v17
    v_and_b32 v73, 0xffff0000, v17
    v_sub_f32 v72, v72, v76
    v_sub_f32 v73, v73, v76
    v_cvt_pk_bf16_f32 v74, v72, v73
    v_lshlrev_b32 v72, 16, v74
    v_and_b32 v73, 0xffff0000, v74
    v_mul_f32 v74, v72, v92
    v_fma_f32 v75, -v74, v84, v72
    v_fma_f32 v72, v75, v92, v74
    v_mul_f32 v74, v73, v92
    v_fma_f32 v75, -v74, v84, v73
    v_fma_f32 v73, v75, v92, v74
    v_cvt_pk_bf16_f32 v104, v72, v73
    v_lshlrev_b32 v72, 16, v22
    v_and_b32 v73, 0xffff0000, v22
    v_sub_f32 v72, v72, v77
    v_sub_f32 v73, v73, v77
    v_cvt_pk_bf16_f32 v74, v72, v73
    v_lshlrev_b32 v72, 16, v74
    v_and_b32 v73, 0xffff0000, v74
    v_mul_f32 v74, v72, v93
    v_fma_f32 v75, -v74, v85, v72
    v_fma_f32 v72, v75, v93, v74
    v_mul_f32 v74, v73, v93
    v_fma_f32 v75, -v74, v85, v73
    v_fma_f32 v73, v75, v93, v74
    v_cvt_pk_bf16_f32 v105, v72, v73
    v_lshlrev_b32 v72, 16, v27
    v_and_b32 v73, 0xffff0000, v27
    v_sub_f32 v72, v72, v78
    v_sub_f32 v73, v73, v78
    v_cvt_pk_bf16_f32 v74, v72, v73
    v_lshlrev_b32 v72, 16, v74
    v_and_b32 v73, 0xffff0000, v74
    v_mul_f32 v74, v72, v94
    v_fma_f32 v75, -v74, v86, v72
    v_fma_f32 v72, v75, v94, v74
    v_mul_f32 v74, v73, v94
    v_fma_f32 v75, -v74, v86, v73
    v_fma_f32 v73, v75, v94, v74
    v_cvt_pk_bf16_f32 v106, v72, v73
    v_lshlrev_b32 v72, 16, v32
    v_and_b32 v73, 0xffff0000, v32
    v_sub_f32 v72, v72, v79
    v_sub_f32 v73, v73, v79
    v_cvt_pk_bf16_f32 v74, v72, v73
    v_lshlrev_b32 v72, 16, v74
    v_and_b32 v73, 0xffff0000, v74
    v_mul_f32 v74, v72, v95
    v_fma_f32 v75, -v74, v87, v72
    v_fma_f32 v72, v75, v95, v74
    v_mul_f32 v74, v73, v95
    v_fma_f32 v75, -v74, v87, v73
    v_fma_f32 v73, v75, v95, v74
    v_cvt_pk_bf16_f32 v107, v72, v73
    v_perm_b32 v112, v105, v104, s20
    v_perm_b32 v116, v105, v104, s21
    v_perm_b32 v113, v107, v106, s20
    v_perm_b32 v117, v107, v106, s21
    buffer_store_dwordx2 v[112:113], v10, s[12:15], s17 offen
    buffer_store_dwordx2 v[116:117], v10, s[12:15], s17 offen offset:64
    s_add_u32 s17, s17, 8192
    s_nop 1
    v_lshlrev_b32 v72, 16, v18
    v_and_b32 v73, 0xffff0000, v18
    v_sub_f32 v72, v72, v76
    v_sub_f32 v73, v73, v76
    v_cvt_pk_bf16_f32 v74, v72, v73
    v_lshlrev_b32 v72, 16, v74
    v_and_b32 v73, 0xffff0000, v74
    v_mul_f32 v74, v72, v92
    v_fma_f32 v75, -v74, v84, v72
    v_fma_f32 v72, v75, v92, v74
    v_mul_f32 v74, v73, v92
    v_fma_f32 v75, -v74, v84, v73
    v_fma_f32 v73, v75, v92, v74
    v_cvt_pk_bf16_f32 v104, v72, v73
    v_lshlrev_b32 v72, 16, v23
    v_and_b32 v73, 0xffff0000, v23
    v_sub_f32 v72, v72, v77
    v_sub_f32 v73, v73, v77
    v_cvt_pk_bf16_f32 v74, v72, v73
    v_lshlrev_b32 v72, 16, v74
    v_and_b32 v73, 0xffff0000, v74
    v_mul_f32 v74, v72, v93
    v_fma_f32 v75, -v74, v85, v72
    v_fma_f32 v72, v75, v93, v74
    v_mul_f32 v74, v73, v93
    v_fma_f32 v75, -v74, v85, v73
    v_fma_f32 v73, v75, v93, v74
    v_cvt_pk_bf16_f32 v105, v72, v73
    v_lshlrev_b32 v72, 16, v28
    v_and_b32 v73, 0xffff0000, v28
    v_sub_f32 v72, v72, v78
    v_sub_f32 v73, v73, v78
    v_cvt_pk_bf16_f32 v74, v72, v73
    v_lshlrev_b32 v72, 16, v74
    v_and_b32 v73, 0xffff0000, v74
    v_mul_f32 v74, v72, v94
    v_fma_f32 v75, -v74, v86, v72
    v_fma_f32 v72, v75, v94, v74
    v_mul_f32 v74, v73, v94
    v_fma_f32 v75, -v74, v86, v73
    v_fma_f32 v73, v75, v94, v74
    v_cvt_pk_bf16_f32 v106, v72, v73
    v_lshlrev_b32 v72, 16, v33
    v_and_b32 v73, 0xffff0000, v33
    v_sub_f32 v72, v72, v79
    v_sub_f32 v73, v73, v79
    v_cvt_pk_bf16_f32 v74, v72, v73
    v_lshlrev_b32 v72, 16, v74
    v_and_b32 v73, 0xffff0000, v74
    v_mul_f32 v74, v72, v95
    v_fma_f32 v75, -v74, v87, v72
    v_fma_f32 v72, v75, v95, v74
    v_mul_f32 v74, v73, v95
    v_fma_f32 v75, -v74, v87, v73
    v_fma_f32 v73, v75, v95, v74
    v_cvt_pk_bf16_f32 v107, v72, v73
    v_perm_b32 v112, v105, v104, s20
    v_perm_b32 v116, v105, v104, s21
    v_perm_b32 v113, v107, v106, s20
    v_perm_b32 v117, v107, v106, s21
    buffer_store_dwordx2 v[112:113], v10, s[12:15], s17 offen
    buffer_store_dwordx2 v[116:117], v10, s[12:15], s17 offen offset:64
    s_add_u32 s17, s17, 8192
    s_nop 1
    v_lshlrev_b32 v72, 16, v19
    v_and_b32 v73, 0xffff0000, v19
    v_sub_f32 v72, v72, v76
    v_sub_f32 v73, v73, v76
    v_cvt_pk_bf16_f32 v74, v72, v73
    v_lshlrev_b32 v72, 16, v74
    v_and_b32 v73, 0xffff0000, v74
    v_mul_f32 v74, v72, v92
    v_fma_f32 v75, -v74, v84, v72
    v_fma_f32 v72, v75, v92, v74
    v_mul_f32 v74, v73, v92
    v_fma_f32 v75, -v74, v84, v73
    v_fma_f32 v73, v75, v92, v74
    v_cvt_pk_bf16_f32 v104, v72, v73
    v_lshlrev_b32 v72, 16, v24
    v_and_b32 v73, 0xffff0000, v24
    v_sub_f32 v72, v72, v77
    v_sub_f32 v73, v73, v77
    v_cvt_pk_bf16_f32 v74, v72, v73
    v_lshlrev_b32 v72, 16, v74
    v_and_b32 v73, 0xffff0000, v74
    v_mul_f32 v74, v72, v93
    v_fma_f32 v75, -v74, v85, v72
    v_fma_f32 v72, v75, v93, v74
    v_mul_f32 v74, v73, v93
    v_fma_f32 v75, -v74, v85, v73
    v_fma_f32 v73, v75, v93, v74
    v_cvt_pk_bf16_f32 v105, v72, v73
    v_lshlrev_b32 v72, 16, v29
    v_and_b32 v73, 0xffff0000, v29
    v_sub_f32 v72, v72, v78
    v_sub_f32 v73, v73, v78
    v_cvt_pk_bf16_f32 v74, v72, v73
    v_lshlrev_b32 v72, 16, v74
    v_and_b32 v73, 0xffff0000, v74
    v_mul_f32 v74, v72, v94
    v_fma_f32 v75, -v74, v86, v72
    v_fma_f32 v72, v75, v94, v74
    v_mul_f32 v74, v73, v94
    v_fma_f32 v75, -v74, v86, v73
    v_fma_f32 v73, v75, v94, v74
    v_cvt_pk_bf16_f32 v106, v72, v73
    v_lshlrev_b32 v72, 16, v34
    v_and_b32 v73, 0xffff0000, v34
    v_sub_f32 v72, v72, v79
    v_sub_f32 v73, v73, v79
    v_cvt_pk_bf16_f32 v74, v72, v73
    v_lshlrev_b32 v72, 16, v74
    v_and_b32 v73, 0xffff0000, v74
    v_mul_f32 v74, v72, v95
    v_fma_f32 v75, -v74, v87, v72
    v_fma_f32 v72, v75, v95, v74
    v_mul_f32 v74, v73, v95
    v_fma_f32 v75, -v74, v87, v73
    v_fma_f32 v73, v75, v95, v74
    v_cvt_pk_bf16_f32 v107, v72, v73
    v_perm_b32 v112, v105, v104, s20
    v_perm_b32 v116, v105, v104, s21
    v_perm_b32 v113, v107, v106, s20
    v_perm_b32 v117, v107, v106, s21
    buffer_store_dwordx2 v[112:113], v10, s[12:15], s17 offen
    buffer_store_dwordx2 v[116:117], v10, s[12:15], s17 offen offset:64
    s_add_u32 s17, s17, 8192
    s_nop 1
    v_lshlrev_b32 v72, 16, v20
    v_and_b32 v73, 0xffff0000, v20
    v_sub_f32 v72, v72, v76
    v_sub_f32 v73, v73, v76
    v_cvt_pk_bf16_f32 v74, v72, v73
    v_lshlrev_b32 v72, 16, v74
    v_and_b32 v73, 0xffff0000, v74
    v_mul_f32 v74, v72, v92
    v_fma_f32 v75, -v74, v84, v72
    v_fma_f32 v72, v75, v92, v74
    v_mul_f32 v74, v73, v92
    v_fma_f32 v75, -v74, v84, v73
    v_fma_f32 v73, v75, v92, v74
    v_cvt_pk_bf16_f32 v104, v72, v73
    v_lshlrev_b32 v72, 16, v25
    v_and_b32 v73, 0xffff0000, v25
    v_sub_f32 v72, v72, v77
    v_sub_f32 v73, v73, v77
    v_cvt_pk_bf16_f32 v74, v72, v73
    v_lshlrev_b32 v72, 16, v74
    v_and_b32 v73, 0xffff0000, v74
    v_mul_f32 v74, v72, v93
    v_fma_f32 v75, -v74, v85, v72
    v_fma_f32 v72, v75, v93, v74
    v_mul_f32 v74, v73, v93
    v_fma_f32 v75, -v74, v85, v73
    v_fma_f32 v73, v75, v93, v74
    v_cvt_pk_bf16_f32 v105, v72, v73
    v_lshlrev_b32 v72, 16, v30
    v_and_b32 v73, 0xffff0000, v30
    v_sub_f32 v72, v72, v78
    v_sub_f32 v73, v73, v78
    v_cvt_pk_bf16_f32 v74, v72, v73
    v_lshlrev_b32 v72, 16, v74
    v_and_b32 v73, 0xffff0000, v74
    v_mul_f32 v74, v72, v94
    v_fma_f32 v75, -v74, v86, v72
    v_fma_f32 v72, v75, v94, v74
    v_mul_f32 v74, v73, v94
    v_fma_f32 v75, -v74, v86, v73
    v_fma_f32 v73, v75, v94, v74
    v_cvt_pk_bf16_f32 v106, v72, v73
    v_lshlrev_b32 v72, 16, v35
    v_and_b32 v73, 0xffff0000, v35
    v_sub_f32 v72, v72, v79
    v_sub_f32 v73, v73, v79
    v_cvt_pk_bf16_f32 v74, v72, v73
    v_lshlrev_b32 v72, 16, v74
    v_and_b32 v73, 0xffff0000, v74
    v_mul_f32 v74, v72, v95
    v_fma_f32 v75, -v74, v87, v72
    v_fma_f32 v72, v75, v95, v74
    v_mul_f32 v74, v73, v95
    v_fma_f32 v75, -v74, v87, v73
    v_fma_f32 v73, v75, v95, v74
    v_cvt_pk_bf16_f32 v107, v72, v73
    v_perm_b32 v112, v105, v104, s20
    v_perm_b32 v116, v105, v104, s21
    v_perm_b32 v113, v107, v106, s20
    v_perm_b32 v117, v107, v106, s21
    buffer_store_dwordx2 v[112:113], v10, s[12:15], s17 offen
    buffer_store_dwordx2 v[116:117], v10, s[12:15], s17 offen offset:64
    s_add_u32 s17, s17, 8192
    s_nop 1
    s_endpgm
wt_start:
    s_load_dwordx4 s[4:7], s[0:1], 64
    s_load_dwordx2 s[20:21], s[0:1], 80
    s_load_dwordx2 s[22:23], s[0:1], 104
    s_waitcnt lgkmcnt(0)
    s_mov_b32 s12, s22
    s_mov_b32 s13, s23
    s_mov_b32 s14, 67108864
    s_mov_b32 s15, 0x00020000
    s_sub_u32 s24, s2, 128
    s_cmp_ge_u32 s24, 68
    s_cbranch_scc0 wt_g
    s_cmp_ge_u32 s24, 136
    s_cbranch_scc0 wt_u
    s_sub_u32 s24, s24, 136
    s_mov_b32 s8, s20
    s_mov_b32 s9, s21
    s_mov_b32 s25, 53687092
    s_mov_b32 s26, 80
    s_mov_b32 s27, 1280
    s_mov_b32 s28, 3456
    s_mov_b32 s29, 37748736
    s_branch wt_go
wt_g:
    s_mov_b32 s8, s4
    s_mov_b32 s9, s5
    s_mov_b32 s25, 19884108
    s_mov_b32 s26, 216
    s_mov_b32 s27, 3456
    s_mov_b32 s28, 1280
    s_mov_b32 s29, 29360128
    s_branch wt_go
wt_u:
    s_sub_u32 s24, s24, 68
    s_mov_b32 s8, s6
    s_mov_b32 s9, s7
    s_mov_b32 s25, 19884108
    s_mov_b32 s26, 216
    s_mov_b32 s27, 3456
    s_mov_b32 s28, 1280
    s_mov_b32 s29, 33554432
wt_go:
    s_mov_b32 s10, 2211840
    s_mov_b32 s11, 0x00020000
    s_lshl_b32 s24, s24, 8
    v_add_u32 v1, s24, v0
    v_cmp_gt_u32 vcc, 17280, v1
    s_and_saveexec_b64 s[30:31], vcc
    s_cbranch_execz ln1_end
    v_mul_hi_u32 v2, v1, s25
    v_mul_lo_u32 v3, v2, s26
    v_sub_u32 v3, v1, v3
    v_mul_lo_u32 v4, v2, s27
    v_lshlrev_b32 v4, 3, v4
    v_lshl_add_u32 v4, v3, 4, v4
    v_mul_lo_u32 v5, v3, s28
    v_lshlrev_b32 v5, 3, v5
    v_lshl_add_u32 v5, v2, 4, v5
    s_mov_b32 s24, 0
    s_mov_b32 s20, 0x05040100
    s_mov_b32 s21, 0x07060302
    buffer_load_dwordx4 v[16:19], v4, s[8:11], s24 offen
    s_add_u32 s24, s24, s27
    buffer_load_dwordx4 v[20:23], v4, s[8:11], s24 offen
    s_add_u32 s24, s24, s27
    buffer_load_dwordx4 v[24:27], v4, s[8:11], s24 offen
    s_add_u32 s24, s24, s27
    buffer_load_dwordx4 v[28:31], v4, s[8:11], s24 offen
    s_add_u32 s24, s24, s27
    buffer_load_dwordx4 v[32:35], v4, s[8:11], s24 offen
    s_add_u32 s24, s24, s27
    buffer_load_dwordx4 v[36:39], v4, s[8:11], s24 offen
    s_add_u32 s24, s24, s27
    buffer_load_dwordx4 v[40:43], v4, s[8:11], s24 offen
    s_add_u32 s24, s24, s27
    buffer_load_dwordx4 v[44:47], v4, s[8:11], s24 offen
    s_add_u32 s24, s24, s27
    s_waitcnt vmcnt(0)
    v_perm_b32 v48, v20, v16, s20
    v_perm_b32 v49, v28, v24, s20
    v_perm_b32 v50, v36, v32, s20
    v_perm_b32 v51, v44, v40, s20
    buffer_store_dwordx4 v[48:51], v5, s[12:15], s29 offen
    s_add_u32 s29, s29, s28
    v_perm_b32 v52, v20, v16, s21
    v_perm_b32 v53, v28, v24, s21
    v_perm_b32 v54, v36, v32, s21
    v_perm_b32 v55, v44, v40, s21
    buffer_store_dwordx4 v[52:55], v5, s[12:15], s29 offen
    s_add_u32 s29, s29, s28
    v_perm_b32 v56, v21, v17, s20
    v_perm_b32 v57, v29, v25, s20
    v_perm_b32 v58, v37, v33, s20
    v_perm_b32 v59, v45, v41, s20
    buffer_store_dwordx4 v[56:59], v5, s[12:15], s29 offen
    s_add_u32 s29, s29, s28
    v_perm_b32 v60, v21, v17, s21
    v_perm_b32 v61, v29, v25, s21
    v_perm_b32 v62, v37, v33, s21
    v_perm_b32 v63, v45, v41, s21
    buffer_store_dwordx4 v[60:63], v5, s[12:15], s29 offen
    s_add_u32 s29, s29, s28
    v_perm_b32 v64, v22, v18, s20
    v_perm_b32 v65, v30, v26, s20
    v_perm_b32 v66, v38, v34, s20
    v_perm_b32 v67, v46, v42, s20
    buffer_store_dwordx4 v[64:67], v5, s[12:15], s29 offen
    s_add_u32 s29, s29, s28
    v_perm_b32 v68, v22, v18, s21
    v_perm_b32 v69, v30, v26, s21
    v_perm_b32 v70, v38, v34, s21
    v_perm_b32 v71, v46, v42, s21
    buffer_store_dwordx4 v[68:71], v5, s[12:15], s29 offen
    s_add_u32 s29, s29, s28
    v_perm_b32 v72, v23, v19, s20
    v_perm_b32 v73, v31, v27, s20
    v_perm_b32 v74, v39, v35, s20
    v_perm_b32 v75, v47, v43, s20
    buffer_store_dwordx4 v[72:75], v5, s[12:15], s29 offen
    s_add_u32 s29, s29, s28
    v_perm_b32 v76, v23, v19, s21
    v_perm_b32 v77, v31, v27, s21
    v_perm_b32 v78, v39, v35, s21
    v_perm_b32 v79, v47, v43, s21
    buffer_store_dwordx4 v[76:79], v5, s[12:15], s29 offen
    s_add_u32 s29, s29, s28
    s_endpgm
kg_start:
    s_load_dwordx4 s[4:7], s[0:1], 8
    s_load_dwordx4 s[20:23], s[0:1], 24
    s_load_dwordx4 s[24:27], s[0:1], 40
    s_load_dwordx2 s[28:29], s[0:1], 104
    s_waitcnt lgkmcnt(0)
    s_mov_b32 s8, s4
    s_mov_b32 s9, s5
    s_mov_b32 s10, 163840
    s_mov_b32 s11, 0x00020000
    s_mov_b32 s12, s6
    s_mov_b32 s13, s7
    s_mov_b32 s14, 163840
    s_mov_b32 s15, 0x00020000
    s_mov_b32 s16, s20
    s_mov_b32 s17, s21
    s_mov_b32 s18, 163840
    s_mov_b32 s19, 0x00020000
    s_mov_b32 s32, s22
    s_mov_b32 s33, s23
    s_mov_b32 s34, 163840
    s_mov_b32 s35, 0x00020000
    s_mov_b32 s36, s24
    s_mov_b32 s37, s25
    s_mov_b32 s38, 1280
    s_mov_b32 s39, 0x00020000
    s_mov_b32 s40, s26
    s_mov_b32 s41, s27
    s_mov_b32 s42, 1280
    s_mov_b32 s43, 0x00020000
    s_mov_b32 s44, s28
    s_mov_b32 s45, s29
    s_mov_b32 s46, 67108864
    s_mov_b32 s47, 0x00020000
    v_and_b32 v1, 63, v0
    v_lshrrev_b32 v2, 6, v0
    v_and_b32 v3, 31, v0
    v_lshrrev_b32 v4, 5, v1
    v_mov_b32 v10, 0
    v_mov_b32 v11, 0
    v_mov_b32 v12, 0
    v_mov_b32 v13, 0
    v_lshlrev_b32 v14, 4, v0
    v_lshlrev_b32 v14, 1, v0
    ds_write_b16 v14, v10 offset:4096
    ds_write_b16 v14, v10 offset:8832
    v_cmp_gt_u32 vcc, 8, v0
    s_and_saveexec_b64 s[48:49], vcc
    ds_write_b16 v14, v10 offset:4608
    ds_write_b16 v14, v10 offset:9344
    s_mov_b64 exec, s[48:49]
    v_cmp_eq_u32 vcc, 0, v0
    s_and_saveexec_b64 s[48:49], vcc
    ds_write_b16 v14, v10 offset:0
    ds_write_b16 v14, v10 offset:4736
    s_mov_b64 exec, s[48:49]
    v_lshl_add_u32 v10, v2, 5, v3
    v_lshlrev_b32 v10, 1, v10
    s_lshl_b32 s30, s2, 8
    s_lshl_b32 s31, s2, 1
    v_mov_b32 v11, 0
    buffer_load_ushort v12, v10, s[8:11], s30 offen
    buffer_load_ushort v13, v10, s[12:15], s30 offen
    buffer_load_ushort v14, v10, s[16:19], s30 offen
    buffer_load_ushort v15, v10, s[32:35], s30 offen
    buffer_load_ushort v16, v11, s[36:39], s31 offen
    buffer_load_ushort v17, v11, s[40:43], s31 offen
    s_waitcnt vmcnt(0)
    v_lshlrev_b32 v12, 16, v12
    v_lshlrev_b32 v13, 16, v13
    v_lshlrev_b32 v14, 16, v14
    v_lshlrev_b32 v15, 16, v15
    v_lshlrev_b32 v16, 16, v16
    v_lshlrev_b32 v17, 16, v17
    v_mul_f32 v16, 0x3fb8aa3b, v16
    v_exp_f32 v16, v16
    v_mul_f32 v12, 0x3fb8aa3b, v12
    v_exp_f32 v12, v12
    s_nop 0
    v_cvt_pk_bf16_f32 v16, v16, v16
    v_lshlrev_b32 v16, 16, v16
    v_cvt_pk_bf16_f32 v12, v12, v12
    v_lshlrev_b32 v12, 16, v12
    v_mul_f32 v12, v12, v16
    v_mul_f32 v12, 0xbfb8aa3b, v12
    v_mul_f32 v13, v13, v16
    v_mul_f32 v13, 0.15915494, v13
    v_mul_f32 v14, v14, v16
    v_mul_f32 v15, v15, v16
    v_mov_b32 v20, v3
    v_subrev_u32 v24, 8, v3
    v_lshlrev_b32 v24, 1, v24
    v_add_u32 v24, 256, v24
    v_cmp_le_u32 vcc, 8, v3
    s_nop 1
    v_cndmask_b32 v20, v20, v24, vcc
    v_subrev_u32 v24, 12, v3
    v_and_b32 v25, 1, v24
    v_lshlrev_b32 v25, 2, v25
    v_lshrrev_b32 v24, 1, v24
    v_lshl_add_u32 v24, v24, 8, v25
    v_add_u32 v24, 512, v24
    v_cmp_le_u32 vcc, 12, v3
    s_nop 1
    v_cndmask_b32 v20, v20, v24, vcc
    v_subrev_u32 v24, 16, v3
    v_lshlrev_b32 v24, 8, v24
    v_add_u32 v24, 1024, v24
    v_cmp_le_u32 vcc, 16, v3
    s_nop 1
    v_cndmask_b32 v20, v20, v24, vcc
    v_cmp_lt_u32 vcc, 20, v3
    s_nop 1
    v_cndmask_b32 v20, v20, 0, vcc
    v_cvt_f32_u32 v20, v20
    v_lshlrev_b32 v21, 3, v3
    v_cvt_f32_u32 v21, v21
    v_cvt_f32_u32 v22, v4
    v_mul_f32 v22, 0.25, v22
    v_sub_f32 v23, 0, v22
    v_mov_b32 v32, 0
    v_mov_b32 v33, 0
    v_mov_b32 v34, 0
    v_mov_b32 v35, 0
    v_mov_b32 v36, 0
    v_mov_b32 v37, 0
    v_mov_b32 v38, 0
    v_mov_b32 v39, 0
    v_mov_b32 v40, 0
    v_mov_b32 v41, 0
    v_mov_b32 v42, 0
    v_mov_b32 v43, 0
    v_mov_b32 v44, 0
    v_mov_b32 v45, 0
    v_mov_b32 v46, 0
    v_mov_b32 v47, 0
    v_lshl_add_u32 v24, v2, 5, v3
    v_lshlrev_b32 v24, 4, v24
    ds_write_b128 v24, v[12:15] offset:25856
    v_lshlrev_b32 v24, 9, v2
    v_lshl_add_u32 v24, v4, 6, v24
    s_waitcnt lgkmcnt(0)
    ds_read_b128 v[80:83], v24 offset:25856
    ds_read_b128 v[84:87], v24 offset:25872
    ds_read_b128 v[88:91], v24 offset:25888
    ds_read_b128 v[92:95], v24 offset:25904
    s_waitcnt lgkmcnt(0)
    v_mul_f32 v96, v80, v20
    v_mul_f32 v97, v81, v20
    v_mul_f32 v100, v80, v21
    v_mul_f32 v101, v81, v21
    v_fract_f32 v97, v97
    v_fract_f32 v101, v101
    v_mul_f32 v104, v84, v20
    v_mul_f32 v105, v85, v20
    v_mul_f32 v108, v84, v21
    v_mul_f32 v109, v85, v21
    v_fract_f32 v105, v105
    v_fract_f32 v109, v109
    v_mul_f32 v112, v88, v20
    v_mul_f32 v113, v89, v20
    v_mul_f32 v116, v88, v21
    v_mul_f32 v117, v89, v21
    v_fract_f32 v113, v113
    v_fract_f32 v117, v117
    v_mul_f32 v120, v92, v20
    v_mul_f32 v121, v93, v20
    v_mul_f32 v124, v92, v21
    v_mul_f32 v125, v93, v21
    v_fract_f32 v121, v121
    v_fract_f32 v125, v125
    v_exp_f32 v96, v96
    v_cos_f32 v98, v97
    v_sin_f32 v99, v97
    v_exp_f32 v100, v100
    v_cos_f32 v102, v101
    v_sin_f32 v103, v101
    v_exp_f32 v104, v104
    v_cos_f32 v106, v105
    v_sin_f32 v107, v105
    v_exp_f32 v108, v108
    v_cos_f32 v110, v109
    v_sin_f32 v111, v109
    v_exp_f32 v112, v112
    v_cos_f32 v114, v113
    v_sin_f32 v115, v113
    v_exp_f32 v116, v116
    v_cos_f32 v118, v117
    v_sin_f32 v119, v117
    v_exp_f32 v120, v120
    v_cos_f32 v122, v121
    v_sin_f32 v123, v121
    v_exp_f32 v124, v124
    v_cos_f32 v126, v125
    v_sin_f32 v127, v125
    v_mul_f32 v98, v98, v96
    v_mul_f32 v99, v99, v96
    v_mul_f32 v102, v102, v100
    v_mul_f32 v103, v103, v100
    v_mul_f32 v96, v82, v98
    v_fma_f32 v96, -v83, v99, v96
    v_mul_f32 v97, v82, v99
    v_fma_f32 v97, v83, v98, v97
    v_sub_f32 v97, 0, v97
    v_cvt_pk_bf16_f32 v64, v96, v97
    v_lshlrev_b32 v100, 16, v64
    v_and_b32 v101, 0xffff0000, v64
    v_sub_f32 v100, v96, v100
    v_sub_f32 v101, v97, v101
    v_cvt_pk_bf16_f32 v68, v100, v101
    v_cvt_pk_bf16_f32 v72, v102, v103
    v_lshlrev_b32 v100, 16, v72
    v_and_b32 v101, 0xffff0000, v72
    v_sub_f32 v100, v102, v100
    v_sub_f32 v101, v103, v101
    v_cvt_pk_bf16_f32 v76, v100, v101
    v_mul_f32 v106, v106, v104
    v_mul_f32 v107, v107, v104
    v_mul_f32 v110, v110, v108
    v_mul_f32 v111, v111, v108
    v_mul_f32 v104, v86, v106
    v_fma_f32 v104, -v87, v107, v104
    v_mul_f32 v105, v86, v107
    v_fma_f32 v105, v87, v106, v105
    v_sub_f32 v105, 0, v105
    v_cvt_pk_bf16_f32 v65, v104, v105
    v_lshlrev_b32 v108, 16, v65
    v_and_b32 v109, 0xffff0000, v65
    v_sub_f32 v108, v104, v108
    v_sub_f32 v109, v105, v109
    v_cvt_pk_bf16_f32 v69, v108, v109
    v_cvt_pk_bf16_f32 v73, v110, v111
    v_lshlrev_b32 v108, 16, v73
    v_and_b32 v109, 0xffff0000, v73
    v_sub_f32 v108, v110, v108
    v_sub_f32 v109, v111, v109
    v_cvt_pk_bf16_f32 v77, v108, v109
    v_mul_f32 v114, v114, v112
    v_mul_f32 v115, v115, v112
    v_mul_f32 v118, v118, v116
    v_mul_f32 v119, v119, v116
    v_mul_f32 v112, v90, v114
    v_fma_f32 v112, -v91, v115, v112
    v_mul_f32 v113, v90, v115
    v_fma_f32 v113, v91, v114, v113
    v_sub_f32 v113, 0, v113
    v_cvt_pk_bf16_f32 v66, v112, v113
    v_lshlrev_b32 v116, 16, v66
    v_and_b32 v117, 0xffff0000, v66
    v_sub_f32 v116, v112, v116
    v_sub_f32 v117, v113, v117
    v_cvt_pk_bf16_f32 v70, v116, v117
    v_cvt_pk_bf16_f32 v74, v118, v119
    v_lshlrev_b32 v116, 16, v74
    v_and_b32 v117, 0xffff0000, v74
    v_sub_f32 v116, v118, v116
    v_sub_f32 v117, v119, v117
    v_cvt_pk_bf16_f32 v78, v116, v117
    v_mul_f32 v122, v122, v120
    v_mul_f32 v123, v123, v120
    v_mul_f32 v126, v126, v124
    v_mul_f32 v127, v127, v124
    v_mul_f32 v120, v94, v122
    v_fma_f32 v120, -v95, v123, v120
    v_mul_f32 v121, v94, v123
    v_fma_f32 v121, v95, v122, v121
    v_sub_f32 v121, 0, v121
    v_cvt_pk_bf16_f32 v67, v120, v121
    v_lshlrev_b32 v124, 16, v67
    v_and_b32 v125, 0xffff0000, v67
    v_sub_f32 v124, v120, v124
    v_sub_f32 v125, v121, v125
    v_cvt_pk_bf16_f32 v71, v124, v125
    v_cvt_pk_bf16_f32 v75, v126, v127
    v_lshlrev_b32 v124, 16, v75
    v_and_b32 v125, 0xffff0000, v75
    v_sub_f32 v124, v126, v124
    v_sub_f32 v125, v127, v125
    v_cvt_pk_bf16_f32 v79, v124, v125
    s_nop 1
    v_mfma_f32_32x32x16_bf16 v[32:47], v[64:67], v[72:75], v[32:47]
    v_mfma_f32_32x32x16_bf16 v[32:47], v[64:67], v[76:79], v[32:47]
    v_mfma_f32_32x32x16_bf16 v[32:47], v[68:71], v[72:75], v[32:47]
    ds_read_b128 v[80:83], v24 offset:25984
    ds_read_b128 v[84:87], v24 offset:26000
    ds_read_b128 v[88:91], v24 offset:26016
    ds_read_b128 v[92:95], v24 offset:26032
    s_waitcnt lgkmcnt(0)
    v_mul_f32 v96, v80, v20
    v_mul_f32 v97, v81, v20
    v_mul_f32 v100, v80, v21
    v_mul_f32 v101, v81, v21
    v_fract_f32 v97, v97
    v_fract_f32 v101, v101
    v_mul_f32 v104, v84, v20
    v_mul_f32 v105, v85, v20
    v_mul_f32 v108, v84, v21
    v_mul_f32 v109, v85, v21
    v_fract_f32 v105, v105
    v_fract_f32 v109, v109
    v_mul_f32 v112, v88, v20
    v_mul_f32 v113, v89, v20
    v_mul_f32 v116, v88, v21
    v_mul_f32 v117, v89, v21
    v_fract_f32 v113, v113
    v_fract_f32 v117, v117
    v_mul_f32 v120, v92, v20
    v_mul_f32 v121, v93, v20
    v_mul_f32 v124, v92, v21
    v_mul_f32 v125, v93, v21
    v_fract_f32 v121, v121
    v_fract_f32 v125, v125
    v_exp_f32 v96, v96
    v_cos_f32 v98, v97
    v_sin_f32 v99, v97
    v_exp_f32 v100, v100
    v_cos_f32 v102, v101
    v_sin_f32 v103, v101
    v_exp_f32 v104, v104
    v_cos_f32 v106, v105
    v_sin_f32 v107, v105
    v_exp_f32 v108, v108
    v_cos_f32 v110, v109
    v_sin_f32 v111, v109
    v_exp_f32 v112, v112
    v_cos_f32 v114, v113
    v_sin_f32 v115, v113
    v_exp_f32 v116, v116
    v_cos_f32 v118, v117
    v_sin_f32 v119, v117
    v_exp_f32 v120, v120
    v_cos_f32 v122, v121
    v_sin_f32 v123, v121
    v_exp_f32 v124, v124
    v_cos_f32 v126, v125
    v_sin_f32 v127, v125
    v_mul_f32 v98, v98, v96
    v_mul_f32 v99, v99, v96
    v_mul_f32 v102, v102, v100
    v_mul_f32 v103, v103, v100
    v_mul_f32 v96, v82, v98
    v_fma_f32 v96, -v83, v99, v96
    v_mul_f32 v97, v82, v99
    v_fma_f32 v97, v83, v98, v97
    v_sub_f32 v97, 0, v97
    v_cvt_pk_bf16_f32 v64, v96, v97
    v_lshlrev_b32 v100, 16, v64
    v_and_b32 v101, 0xffff0000, v64
    v_sub_f32 v100, v96, v100
    v_sub_f32 v101, v97, v101
    v_cvt_pk_bf16_f32 v68, v100, v101
    v_cvt_pk_bf16_f32 v72, v102, v103
    v_lshlrev_b32 v100, 16, v72
    v_and_b32 v101, 0xffff0000, v72
    v_sub_f32 v100, v102, v100
    v_sub_f32 v101, v103, v101
    v_cvt_pk_bf16_f32 v76, v100, v101
    v_mul_f32 v106, v106, v104
    v_mul_f32 v107, v107, v104
    v_mul_f32 v110, v110, v108
    v_mul_f32 v111, v111, v108
    v_mul_f32 v104, v86, v106
    v_fma_f32 v104, -v87, v107, v104
    v_mul_f32 v105, v86, v107
    v_fma_f32 v105, v87, v106, v105
    v_sub_f32 v105, 0, v105
    v_cvt_pk_bf16_f32 v65, v104, v105
    v_lshlrev_b32 v108, 16, v65
    v_and_b32 v109, 0xffff0000, v65
    v_sub_f32 v108, v104, v108
    v_sub_f32 v109, v105, v109
    v_cvt_pk_bf16_f32 v69, v108, v109
    v_cvt_pk_bf16_f32 v73, v110, v111
    v_lshlrev_b32 v108, 16, v73
    v_and_b32 v109, 0xffff0000, v73
    v_sub_f32 v108, v110, v108
    v_sub_f32 v109, v111, v109
    v_cvt_pk_bf16_f32 v77, v108, v109
    v_mul_f32 v114, v114, v112
    v_mul_f32 v115, v115, v112
    v_mul_f32 v118, v118, v116
    v_mul_f32 v119, v119, v116
    v_mul_f32 v112, v90, v114
    v_fma_f32 v112, -v91, v115, v112
    v_mul_f32 v113, v90, v115
    v_fma_f32 v113, v91, v114, v113
    v_sub_f32 v113, 0, v113
    v_cvt_pk_bf16_f32 v66, v112, v113
    v_lshlrev_b32 v116, 16, v66
    v_and_b32 v117, 0xffff0000, v66
    v_sub_f32 v116, v112, v116
    v_sub_f32 v117, v113, v117
    v_cvt_pk_bf16_f32 v70, v116, v117
    v_cvt_pk_bf16_f32 v74, v118, v119
    v_lshlrev_b32 v116, 16, v74
    v_and_b32 v117, 0xffff0000, v74
    v_sub_f32 v116, v118, v116
    v_sub_f32 v117, v119, v117
    v_cvt_pk_bf16_f32 v78, v116, v117
    v_mul_f32 v122, v122, v120
    v_mul_f32 v123, v123, v120
    v_mul_f32 v126, v126, v124
    v_mul_f32 v127, v127, v124
    v_mul_f32 v120, v94, v122
    v_fma_f32 v120, -v95, v123, v120
    v_mul_f32 v121, v94, v123
    v_fma_f32 v121, v95, v122, v121
    v_sub_f32 v121, 0, v121
    v_cvt_pk_bf16_f32 v67, v120, v121
    v_lshlrev_b32 v124, 16, v67
    v_and_b32 v125, 0xffff0000, v67
    v_sub_f32 v124, v120, v124
    v_sub_f32 v125, v121, v125
    v_cvt_pk_bf16_f32 v71, v124, v125
    v_cvt_pk_bf16_f32 v75, v126, v127
    v_lshlrev_b32 v124, 16, v75
    v_and_b32 v125, 0xffff0000, v75
    v_sub_f32 v124, v126, v124
    v_sub_f32 v125, v127, v125
    v_cvt_pk_bf16_f32 v79, v124, v125
    s_nop 1
    v_mfma_f32_32x32x16_bf16 v[32:47], v[64:67], v[72:75], v[32:47]
    v_mfma_f32_32x32x16_bf16 v[32:47], v[64:67], v[76:79], v[32:47]
    v_mfma_f32_32x32x16_bf16 v[32:47], v[68:71], v[72:75], v[32:47]
    ds_read_b128 v[80:83], v24 offset:26112
    ds_read_b128 v[84:87], v24 offset:26128
    ds_read_b128 v[88:91], v24 offset:26144
    ds_read_b128 v[92:95], v24 offset:26160
    s_waitcnt lgkmcnt(0)
    v_mul_f32 v96, v80, v20
    v_mul_f32 v97, v81, v20
    v_mul_f32 v100, v80, v21
    v_mul_f32 v101, v81, v21
    v_fract_f32 v97, v97
    v_fract_f32 v101, v101
    v_mul_f32 v104, v84, v20
    v_mul_f32 v105, v85, v20
    v_mul_f32 v108, v84, v21
    v_mul_f32 v109, v85, v21
    v_fract_f32 v105, v105
    v_fract_f32 v109, v109
    v_mul_f32 v112, v88, v20
    v_mul_f32 v113, v89, v20
    v_mul_f32 v116, v88, v21
    v_mul_f32 v117, v89, v21
    v_fract_f32 v113, v113
    v_fract_f32 v117, v117
    v_mul_f32 v120, v92, v20
    v_mul_f32 v121, v93, v20
    v_mul_f32 v124, v92, v21
    v_mul_f32 v125, v93, v21
    v_fract_f32 v121, v121
    v_fract_f32 v125, v125
    v_exp_f32 v96, v96
    v_cos_f32 v98, v97
    v_sin_f32 v99, v97
    v_exp_f32 v100, v100
    v_cos_f32 v102, v101
    v_sin_f32 v103, v101
    v_exp_f32 v104, v104
    v_cos_f32 v106, v105
    v_sin_f32 v107, v105
    v_exp_f32 v108, v108
    v_cos_f32 v110, v109
    v_sin_f32 v111, v109
    v_exp_f32 v112, v112
    v_cos_f32 v114, v113
    v_sin_f32 v115, v113
    v_exp_f32 v116, v116
    v_cos_f32 v118, v117
    v_sin_f32 v119, v117
    v_exp_f32 v120, v120
    v_cos_f32 v122, v121
    v_sin_f32 v123, v121
    v_exp_f32 v124, v124
    v_cos_f32 v126, v125
    v_sin_f32 v127, v125
    v_mul_f32 v98, v98, v96
    v_mul_f32 v99, v99, v96
    v_mul_f32 v102, v102, v100
    v_mul_f32 v103, v103, v100
    v_mul_f32 v96, v82, v98
    v_fma_f32 v96, -v83, v99, v96
    v_mul_f32 v97, v82, v99
    v_fma_f32 v97, v83, v98, v97
    v_sub_f32 v97, 0, v97
    v_cvt_pk_bf16_f32 v64, v96, v97
    v_lshlrev_b32 v100, 16, v64
    v_and_b32 v101, 0xffff0000, v64
    v_sub_f32 v100, v96, v100
    v_sub_f32 v101, v97, v101
    v_cvt_pk_bf16_f32 v68, v100, v101
    v_cvt_pk_bf16_f32 v72, v102, v103
    v_lshlrev_b32 v100, 16, v72
    v_and_b32 v101, 0xffff0000, v72
    v_sub_f32 v100, v102, v100
    v_sub_f32 v101, v103, v101
    v_cvt_pk_bf16_f32 v76, v100, v101
    v_mul_f32 v106, v106, v104
    v_mul_f32 v107, v107, v104
    v_mul_f32 v110, v110, v108
    v_mul_f32 v111, v111, v108
    v_mul_f32 v104, v86, v106
    v_fma_f32 v104, -v87, v107, v104
    v_mul_f32 v105, v86, v107
    v_fma_f32 v105, v87, v106, v105
    v_sub_f32 v105, 0, v105
    v_cvt_pk_bf16_f32 v65, v104, v105
    v_lshlrev_b32 v108, 16, v65
    v_and_b32 v109, 0xffff0000, v65
    v_sub_f32 v108, v104, v108
    v_sub_f32 v109, v105, v109
    v_cvt_pk_bf16_f32 v69, v108, v109
    v_cvt_pk_bf16_f32 v73, v110, v111
    v_lshlrev_b32 v108, 16, v73
    v_and_b32 v109, 0xffff0000, v73
    v_sub_f32 v108, v110, v108
    v_sub_f32 v109, v111, v109
    v_cvt_pk_bf16_f32 v77, v108, v109
    v_mul_f32 v114, v114, v112
    v_mul_f32 v115, v115, v112
    v_mul_f32 v118, v118, v116
    v_mul_f32 v119, v119, v116
    v_mul_f32 v112, v90, v114
    v_fma_f32 v112, -v91, v115, v112
    v_mul_f32 v113, v90, v115
    v_fma_f32 v113, v91, v114, v113
    v_sub_f32 v113, 0, v113
    v_cvt_pk_bf16_f32 v66, v112, v113
    v_lshlrev_b32 v116, 16, v66
    v_and_b32 v117, 0xffff0000, v66
    v_sub_f32 v116, v112, v116
    v_sub_f32 v117, v113, v117
    v_cvt_pk_bf16_f32 v70, v116, v117
    v_cvt_pk_bf16_f32 v74, v118, v119
    v_lshlrev_b32 v116, 16, v74
    v_and_b32 v117, 0xffff0000, v74
    v_sub_f32 v116, v118, v116
    v_sub_f32 v117, v119, v117
    v_cvt_pk_bf16_f32 v78, v116, v117
    v_mul_f32 v122, v122, v120
    v_mul_f32 v123, v123, v120
    v_mul_f32 v126, v126, v124
    v_mul_f32 v127, v127, v124
    v_mul_f32 v120, v94, v122
    v_fma_f32 v120, -v95, v123, v120
    v_mul_f32 v121, v94, v123
    v_fma_f32 v121, v95, v122, v121
    v_sub_f32 v121, 0, v121
    v_cvt_pk_bf16_f32 v67, v120, v121
    v_lshlrev_b32 v124, 16, v67
    v_and_b32 v125, 0xffff0000, v67
    v_sub_f32 v124, v120, v124
    v_sub_f32 v125, v121, v125
    v_cvt_pk_bf16_f32 v71, v124, v125
    v_cvt_pk_bf16_f32 v75, v126, v127
    v_lshlrev_b32 v124, 16, v75
    v_and_b32 v125, 0xffff0000, v75
    v_sub_f32 v124, v126, v124
    v_sub_f32 v125, v127, v125
    v_cvt_pk_bf16_f32 v79, v124, v125
    s_nop 1
    v_mfma_f32_32x32x16_bf16 v[32:47], v[64:67], v[72:75], v[32:47]
    v_mfma_f32_32x32x16_bf16 v[32:47], v[64:67], v[76:79], v[32:47]
    v_mfma_f32_32x32x16_bf16 v[32:47], v[68:71], v[72:75], v[32:47]
    ds_read_b128 v[80:83], v24 offset:26240
    ds_read_b128 v[84:87], v24 offset:26256
    ds_read_b128 v[88:91], v24 offset:26272
    ds_read_b128 v[92:95], v24 offset:26288
    s_waitcnt lgkmcnt(0)
    v_mul_f32 v96, v80, v20
    v_mul_f32 v97, v81, v20
    v_mul_f32 v100, v80, v21
    v_mul_f32 v101, v81, v21
    v_fract_f32 v97, v97
    v_fract_f32 v101, v101
    v_mul_f32 v104, v84, v20
    v_mul_f32 v105, v85, v20
    v_mul_f32 v108, v84, v21
    v_mul_f32 v109, v85, v21
    v_fract_f32 v105, v105
    v_fract_f32 v109, v109
    v_mul_f32 v112, v88, v20
    v_mul_f32 v113, v89, v20
    v_mul_f32 v116, v88, v21
    v_mul_f32 v117, v89, v21
    v_fract_f32 v113, v113
    v_fract_f32 v117, v117
    v_mul_f32 v120, v92, v20
    v_mul_f32 v121, v93, v20
    v_mul_f32 v124, v92, v21
    v_mul_f32 v125, v93, v21
    v_fract_f32 v121, v121
    v_fract_f32 v125, v125
    v_exp_f32 v96, v96
    v_cos_f32 v98, v97
    v_sin_f32 v99, v97
    v_exp_f32 v100, v100
    v_cos_f32 v102, v101
    v_sin_f32 v103, v101
    v_exp_f32 v104, v104
    v_cos_f32 v106, v105
    v_sin_f32 v107, v105
    v_exp_f32 v108, v108
    v_cos_f32 v110, v109
    v_sin_f32 v111, v109
    v_exp_f32 v112, v112
    v_cos_f32 v114, v113
    v_sin_f32 v115, v113
    v_exp_f32 v116, v116
    v_cos_f32 v118, v117
    v_sin_f32 v119, v117
    v_exp_f32 v120, v120
    v_cos_f32 v122, v121
    v_sin_f32 v123, v121
    v_exp_f32 v124, v124
    v_cos_f32 v126, v125
    v_sin_f32 v127, v125
    v_mul_f32 v98, v98, v96
    v_mul_f32 v99, v99, v96
    v_mul_f32 v102, v102, v100
    v_mul_f32 v103, v103, v100
    v_mul_f32 v96, v82, v98
    v_fma_f32 v96, -v83, v99, v96
    v_mul_f32 v97, v82, v99
    v_fma_f32 v97, v83, v98, v97
    v_sub_f32 v97, 0, v97
    v_cvt_pk_bf16_f32 v64, v96, v97
    v_lshlrev_b32 v100, 16, v64
    v_and_b32 v101, 0xffff0000, v64
    v_sub_f32 v100, v96, v100
    v_sub_f32 v101, v97, v101
    v_cvt_pk_bf16_f32 v68, v100, v101
    v_cvt_pk_bf16_f32 v72, v102, v103
    v_lshlrev_b32 v100, 16, v72
    v_and_b32 v101, 0xffff0000, v72
    v_sub_f32 v100, v102, v100
    v_sub_f32 v101, v103, v101
    v_cvt_pk_bf16_f32 v76, v100, v101
    v_mul_f32 v106, v106, v104
    v_mul_f32 v107, v107, v104
    v_mul_f32 v110, v110, v108
    v_mul_f32 v111, v111, v108
    v_mul_f32 v104, v86, v106
    v_fma_f32 v104, -v87, v107, v104
    v_mul_f32 v105, v86, v107
    v_fma_f32 v105, v87, v106, v105
    v_sub_f32 v105, 0, v105
    v_cvt_pk_bf16_f32 v65, v104, v105
    v_lshlrev_b32 v108, 16, v65
    v_and_b32 v109, 0xffff0000, v65
    v_sub_f32 v108, v104, v108
    v_sub_f32 v109, v105, v109
    v_cvt_pk_bf16_f32 v69, v108, v109
    v_cvt_pk_bf16_f32 v73, v110, v111
    v_lshlrev_b32 v108, 16, v73
    v_and_b32 v109, 0xffff0000, v73
    v_sub_f32 v108, v110, v108
    v_sub_f32 v109, v111, v109
    v_cvt_pk_bf16_f32 v77, v108, v109
    v_mul_f32 v114, v114, v112
    v_mul_f32 v115, v115, v112
    v_mul_f32 v118, v118, v116
    v_mul_f32 v119, v119, v116
    v_mul_f32 v112, v90, v114
    v_fma_f32 v112, -v91, v115, v112
    v_mul_f32 v113, v90, v115
    v_fma_f32 v113, v91, v114, v113
    v_sub_f32 v113, 0, v113
    v_cvt_pk_bf16_f32 v66, v112, v113
    v_lshlrev_b32 v116, 16, v66
    v_and_b32 v117, 0xffff0000, v66
    v_sub_f32 v116, v112, v116
    v_sub_f32 v117, v113, v117
    v_cvt_pk_bf16_f32 v70, v116, v117
    v_cvt_pk_bf16_f32 v74, v118, v119
    v_lshlrev_b32 v116, 16, v74
    v_and_b32 v117, 0xffff0000, v74
    v_sub_f32 v116, v118, v116
    v_sub_f32 v117, v119, v117
    v_cvt_pk_bf16_f32 v78, v116, v117
    v_mul_f32 v122, v122, v120
    v_mul_f32 v123, v123, v120
    v_mul_f32 v126, v126, v124
    v_mul_f32 v127, v127, v124
    v_mul_f32 v120, v94, v122
    v_fma_f32 v120, -v95, v123, v120
    v_mul_f32 v121, v94, v123
    v_fma_f32 v121, v95, v122, v121
    v_sub_f32 v121, 0, v121
    v_cvt_pk_bf16_f32 v67, v120, v121
    v_lshlrev_b32 v124, 16, v67
    v_and_b32 v125, 0xffff0000, v67
    v_sub_f32 v124, v120, v124
    v_sub_f32 v125, v121, v125
    v_cvt_pk_bf16_f32 v71, v124, v125
    v_cvt_pk_bf16_f32 v75, v126, v127
    v_lshlrev_b32 v124, 16, v75
    v_and_b32 v125, 0xffff0000, v75
    v_sub_f32 v124, v126, v124
    v_sub_f32 v125, v127, v125
    v_cvt_pk_bf16_f32 v79, v124, v125
    s_nop 1
    v_mfma_f32_32x32x16_bf16 v[32:47], v[64:67], v[72:75], v[32:47]
    v_mfma_f32_32x32x16_bf16 v[32:47], v[64:67], v[76:79], v[32:47]
    v_mfma_f32_32x32x16_bf16 v[32:47], v[68:71], v[72:75], v[32:47]
    s_nop 15
    s_nop 7
    v_lshlrev_b32 v24, 12, v2
    v_lshl_add_u32 v24, v4, 9, v24
    v_lshl_add_u32 v24, v3, 2, v24
    ds_write_b32 v24, v32 offset:9472
    ds_write_b32 v24, v33 offset:9600
    ds_write_b32 v24, v34 offset:9728
    ds_write_b32 v24, v35 offset:9856
    ds_write_b32 v24, v36 offset:10496
    ds_write_b32 v24, v37 offset:10624
    ds_write_b32 v24, v38 offset:10752
    ds_write_b32 v24, v39 offset:10880
    ds_write_b32 v24, v40 offset:11520
    ds_write_b32 v24, v41 offset:11648
    ds_write_b32 v24, v42 offset:11776
    ds_write_b32 v24, v43 offset:11904
    ds_write_b32 v24, v44 offset:12544
    ds_write_b32 v24, v45 offset:12672
    ds_write_b32 v24, v46 offset:12800
    ds_write_b32 v24, v47 offset:12928
    s_waitcnt lgkmcnt(0)
    s_barrier
    v_lshlrev_b32 v24, 2, v0
    ds_read_b32 v32, v24 offset:9472
    ds_read_b32 v33, v24 offset:13568
    ds_read_b32 v34, v24 offset:17664
    ds_read_b32 v35, v24 offset:21760
    s_waitcnt lgkmcnt(0)
    v_add_f32 v32, v32, v33
    v_add_f32 v34, v34, v35
    v_add_f32 v32, v32, v34
    v_add_f32 v32, v32, v32
    ds_write_b32 v24, v32 offset:25856
    ds_read_b32 v32, v24 offset:10496
    ds_read_b32 v33, v24 offset:14592
    ds_read_b32 v34, v24 offset:18688
    ds_read_b32 v35, v24 offset:22784
    s_waitcnt lgkmcnt(0)
    v_add_f32 v32, v32, v33
    v_add_f32 v34, v34, v35
    v_add_f32 v32, v32, v34
    v_add_f32 v32, v32, v32
    ds_write_b32 v24, v32 offset:26880
    ds_read_b32 v32, v24 offset:11520
    ds_read_b32 v33, v24 offset:15616
    ds_read_b32 v34, v24 offset:19712
    ds_read_b32 v35, v24 offset:23808
    s_waitcnt lgkmcnt(0)
    v_add_f32 v32, v32, v33
    v_add_f32 v34, v34, v35
    v_add_f32 v32, v32, v34
    v_add_f32 v32, v32, v32
    ds_write_b32 v24, v32 offset:27904
    ds_read_b32 v32, v24 offset:12544
    ds_read_b32 v33, v24 offset:16640
    ds_read_b32 v34, v24 offset:20736
    ds_read_b32 v35, v24 offset:24832
    s_waitcnt lgkmcnt(0)
    v_add_f32 v32, v32, v33
    v_add_f32 v34, v34, v35
    v_add_f32 v32, v32, v34
    v_add_f32 v32, v32, v32
    ds_write_b32 v24, v32 offset:28928
    s_waitcnt lgkmcnt(0)
    s_barrier
    v_add_u32 v24, 0, v0
    v_lshrrev_b32 v25, 3, v24
    v_and_b32 v26, 7, v24
    v_lshl_add_u32 v25, v26, 5, v25
    v_lshlrev_b32 v25, 2, v25
    ds_read_b32 v26, v25 offset:25856
    v_sub_u32 v24, 2047, v24
    v_lshlrev_b32 v24, 1, v24
    s_waitcnt lgkmcnt(0)
    v_cvt_pk_bf16_f32 v27, v26, v26
    v_lshlrev_b32 v27, 16, v27
    v_sub_f32 v28, v26, v27
    v_cvt_pk_bf16_f32 v28, v28, v28
    ds_write_b16_d16_hi v24, v27 offset:0
    ds_write_b16 v24, v28 offset:4736
    v_add_u32 v24, 256, v0
    v_lshrrev_b32 v25, 1, v24
    v_and_b32 v25, 1, v25
    v_add3_u32 v25, v24, v25, 0
    v_lshrrev_b32 v25, 1, v25
    v_lshlrev_b32 v25, 1, v25
    v_subrev_u32 v26, 256, v25
    v_lshrrev_b32 v27, 3, v26
    v_and_b32 v26, 7, v26
    v_lshrrev_b32 v26, 1, v26
    v_add_u32 v26, 8, v26
    v_lshl_add_u32 v27, v26, 5, v27
    v_cmp_eq_u32 vcc, 512, v25
    v_mov_b32 v26, 384
    s_nop 1
    v_cndmask_b32 v25, v27, v26, vcc
    v_lshlrev_b32 v25, 2, v25
    ds_read_b32 v26, v25 offset:25856
    v_sub_u32 v24, 2047, v24
    v_lshlrev_b32 v24, 1, v24
    s_waitcnt lgkmcnt(0)
    v_cvt_pk_bf16_f32 v27, v26, v26
    v_lshlrev_b32 v27, 16, v27
    v_sub_f32 v28, v26, v27
    v_cvt_pk_bf16_f32 v28, v28, v28
    ds_write_b16_d16_hi v24, v27 offset:0
    ds_write_b16 v24, v28 offset:4736
    v_add_u32 v24, 512, v0
    v_lshrrev_b32 v25, 2, v24
    v_and_b32 v25, 1, v25
    v_add3_u32 v25, v24, v25, 1
    v_lshrrev_b32 v25, 2, v25
    v_lshlrev_b32 v25, 2, v25
    v_subrev_u32 v26, 512, v25
    v_lshrrev_b32 v28, 8, v26
    v_and_b32 v26, 255, v26
    v_lshrrev_b32 v27, 3, v26
    v_and_b32 v26, 7, v26
    v_lshrrev_b32 v26, 2, v26
    v_lshl_add_u32 v26, v28, 1, v26
    v_add_u32 v26, 12, v26
    v_lshl_add_u32 v27, v26, 5, v27
    v_mov_b32 v28, 1024
    v_cmp_eq_u32 vcc, v28, v25
    v_mov_b32 v26, 512
    s_nop 1
    v_cndmask_b32 v25, v27, v26, vcc
    v_lshlrev_b32 v25, 2, v25
    ds_read_b32 v26, v25 offset:25856
    v_sub_u32 v24, 2047, v24
    v_lshlrev_b32 v24, 1, v24
    s_waitcnt lgkmcnt(0)
    v_cvt_pk_bf16_f32 v27, v26, v26
    v_lshlrev_b32 v27, 16, v27
    v_sub_f32 v28, v26, v27
    v_cvt_pk_bf16_f32 v28, v28, v28
    ds_write_b16_d16_hi v24, v27 offset:0
    ds_write_b16 v24, v28 offset:4736
    v_add_u32 v24, 768, v0
    v_lshrrev_b32 v25, 2, v24
    v_and_b32 v25, 1, v25
    v_add3_u32 v25, v24, v25, 1
    v_lshrrev_b32 v25, 2, v25
    v_lshlrev_b32 v25, 2, v25
    v_subrev_u32 v26, 512, v25
    v_lshrrev_b32 v28, 8, v26
    v_and_b32 v26, 255, v26
    v_lshrrev_b32 v27, 3, v26
    v_and_b32 v26, 7, v26
    v_lshrrev_b32 v26, 2, v26
    v_lshl_add_u32 v26, v28, 1, v26
    v_add_u32 v26, 12, v26
    v_lshl_add_u32 v27, v26, 5, v27
    v_mov_b32 v28, 1024
    v_cmp_eq_u32 vcc, v28, v25
    v_mov_b32 v26, 512
    s_nop 1
    v_cndmask_b32 v25, v27, v26, vcc
    v_lshlrev_b32 v25, 2, v25
    ds_read_b32 v26, v25 offset:25856
    v_sub_u32 v24, 2047, v24
    v_lshlrev_b32 v24, 1, v24
    s_waitcnt lgkmcnt(0)
    v_cvt_pk_bf16_f32 v27, v26, v26
    v_lshlrev_b32 v27, 16, v27
    v_sub_f32 v28, v26, v27
    v_cvt_pk_bf16_f32 v28, v28, v28
    ds_write_b16_d16_hi v24, v27 offset:0
    ds_write_b16 v24, v28 offset:4736
    v_add_u32 v24, 1024, v0
    v_lshrrev_b32 v25, 3, v24
    v_and_b32 v25, 1, v25
    v_add3_u32 v25, v24, v25, 3
    v_lshrrev_b32 v25, 3, v25
    v_lshlrev_b32 v25, 3, v25
    v_subrev_u32 v26, 1024, v25
    v_lshrrev_b32 v28, 8, v26
    v_and_b32 v26, 255, v26
    v_lshrrev_b32 v27, 3, v26
    v_add_u32 v26, 16, v28
    v_lshl_add_u32 v25, v26, 5, v27
    v_lshlrev_b32 v25, 2, v25
    ds_read_b32 v26, v25 offset:25856
    v_sub_u32 v24, 2047, v24
    v_lshlrev_b32 v24, 1, v24
    s_waitcnt lgkmcnt(0)
    v_cvt_pk_bf16_f32 v27, v26, v26
    v_lshlrev_b32 v27, 16, v27
    v_sub_f32 v28, v26, v27
    v_cvt_pk_bf16_f32 v28, v28, v28
    ds_write_b16_d16_hi v24, v27 offset:0
    ds_write_b16 v24, v28 offset:4736
    v_add_u32 v24, 1280, v0
    v_lshrrev_b32 v25, 3, v24
    v_and_b32 v25, 1, v25
    v_add3_u32 v25, v24, v25, 3
    v_lshrrev_b32 v25, 3, v25
    v_lshlrev_b32 v25, 3, v25
    v_subrev_u32 v26, 1024, v25
    v_lshrrev_b32 v28, 8, v26
    v_and_b32 v26, 255, v26
    v_lshrrev_b32 v27, 3, v26
    v_add_u32 v26, 16, v28
    v_lshl_add_u32 v25, v26, 5, v27
    v_lshlrev_b32 v25, 2, v25
    ds_read_b32 v26, v25 offset:25856
    v_sub_u32 v24, 2047, v24
    v_lshlrev_b32 v24, 1, v24
    s_waitcnt lgkmcnt(0)
    v_cvt_pk_bf16_f32 v27, v26, v26
    v_lshlrev_b32 v27, 16, v27
    v_sub_f32 v28, v26, v27
    v_cvt_pk_bf16_f32 v28, v28, v28
    ds_write_b16_d16_hi v24, v27 offset:0
    ds_write_b16 v24, v28 offset:4736
    v_add_u32 v24, 1536, v0
    v_lshrrev_b32 v25, 3, v24
    v_and_b32 v25, 1, v25
    v_add3_u32 v25, v24, v25, 3
    v_lshrrev_b32 v25, 3, v25
    v_lshlrev_b32 v25, 3, v25
    v_subrev_u32 v26, 1024, v25
    v_lshrrev_b32 v28, 8, v26
    v_and_b32 v26, 255, v26
    v_lshrrev_b32 v27, 3, v26
    v_add_u32 v26, 16, v28
    v_lshl_add_u32 v25, v26, 5, v27
    v_lshlrev_b32 v25, 2, v25
    ds_read_b32 v26, v25 offset:25856
    v_sub_u32 v24, 2047, v24
    v_lshlrev_b32 v24, 1, v24
    s_waitcnt lgkmcnt(0)
    v_cvt_pk_bf16_f32 v27, v26, v26
    v_lshlrev_b32 v27, 16, v27
    v_sub_f32 v28, v26, v27
    v_cvt_pk_bf16_f32 v28, v28, v28
    ds_write_b16_d16_hi v24, v27 offset:0
    ds_write_b16 v24, v28 offset:4736
    v_add_u32 v24, 1792, v0
    v_lshrrev_b32 v25, 3, v24
    v_and_b32 v25, 1, v25
    v_add3_u32 v25, v24, v25, 3
    v_lshrrev_b32 v25, 3, v25
    v_lshlrev_b32 v25, 3, v25
    v_subrev_u32 v26, 1024, v25
    v_lshrrev_b32 v28, 8, v26
    v_and_b32 v26, 255, v26
    v_lshrrev_b32 v27, 3, v26
    v_add_u32 v26, 16, v28
    v_lshl_add_u32 v25, v26, 5, v27
    v_lshlrev_b32 v25, 2, v25
    ds_read_b32 v26, v25 offset:25856
    v_sub_u32 v24, 2047, v24
    v_lshlrev_b32 v24, 1, v24
    s_waitcnt lgkmcnt(0)
    v_cvt_pk_bf16_f32 v27, v26, v26
    v_lshlrev_b32 v27, 16, v27
    v_sub_f32 v28, v26, v27
    v_cvt_pk_bf16_f32 v28, v28, v28
    ds_write_b16_d16_hi v24, v27 offset:0
    ds_write_b16 v24, v28 offset:4736
    s_waitcnt lgkmcnt(0)
    s_barrier
    s_mul_i32 s30, s2, 9472
    s_add_u32 s30, s30, 41943040
    v_lshlrev_b32 v24, 4, v0
    ds_read_b128 v[32:35], v24 offset:0
    s_waitcnt lgkmcnt(0)
    buffer_store_dwordx4 v[32:35], v24, s[44:47], s30 offen
    s_add_u32 s30, s30, 4096
    s_nop 1
    ds_read_b128 v[32:35], v24 offset:4096
    s_waitcnt lgkmcnt(0)
    buffer_store_dwordx4 v[32:35], v24, s[44:47], s30 offen
    s_add_u32 s30, s30, 4096
    s_nop 1
    v_cmp_gt_u32 vcc, 80, v0
    s_and_saveexec_b64 s[48:49], vcc
    s_cbranch_execz ln1_end
    ds_read_b128 v[32:35], v24 offset:8192
    s_waitcnt lgkmcnt(0)
    buffer_store_dwordx4 v[32:35], v24, s[44:47], s30 offen
    s_add_u32 s30, s30, 4096
    s_nop 1
    s_branch ln1_end
ln1_end:
    s_endpgm
.globl conv_kernel
.p2align 8
.type conv_kernel,@function
conv_kernel:
    s_cmp_ge_u32 s2, 640
    s_cbranch_scc1 conv_end
    s_load_dwordx2 s[28:29], s[0:1], 104
    s_waitcnt lgkmcnt(0)
    s_mov_b32 s44, s28
    s_mov_b32 s45, s29
    s_mov_b32 s46, 67108864
    s_mov_b32 s47, 0x00020000
    v_and_b32 v1, 63, v0
    v_lshrrev_b32 v2, 6, v0
    v_and_b32 v3, 31, v0
    v_lshrrev_b32 v4, 5, v1
    v_mov_b32 v10, 0
    v_mov_b32 v11, 0
    v_mov_b32 v12, 0
    v_mov_b32 v13, 0
    v_lshlrev_b32 v14, 4, v0
    s_mul_i32 s30, s2, 9472
    s_add_u32 s30, s30, 41943040
    s_add_u32 s31, s30, 4096
    s_add_u32 s32, s30, 8192
    buffer_load_dwordx4 v[44:47], v14, s[44:47], s30 offen
    buffer_load_dwordx4 v[48:51], v14, s[44:47], s31 offen
    buffer_load_dwordx4 v[52:55], v14, s[44:47], s32 offen
    v_cmp_gt_u32 vcc, 32, v0
    s_and_saveexec_b64 s[48:49], vcc
    ds_write_b128 v14, v[10:13] offset:42496
    s_mov_b64 exec, s[48:49]
    s_lshl_b32 s30, s2, 6
    v_lshlrev_b32 v24, 4, v0
    v_lshrrev_b32 v26, 2, v0
    v_mul_u32_u24 v26, 40960, v26
    v_and_b32 v25, 3, v0
    v_lshl_add_u32 v26, v25, 4, v26
    buffer_load_dwordx4 v[36:39], v26, s[44:47], s30 offen
    v_subrev_u32 v25, 1, v0
    v_max_i32 v25, 0, v25
    v_lshrrev_b32 v27, 2, v25
    v_mul_u32_u24 v27, 40960, v27
    v_and_b32 v25, 3, v25
    v_lshl_add_u32 v27, v25, 4, v27
    v_mov_b32 v140, v26
    buffer_load_dwordx4 v[32:35], v27, s[44:47], s30 offen
    s_waitcnt vmcnt(0)
    ds_write_b128 v14, v[44:47]
    ds_write_b128 v14, v[48:51] offset:4096
    v_cmp_gt_u32 vcc, 80, v0
    s_and_saveexec_b64 s[48:49], vcc
    ds_write_b128 v14, v[52:55] offset:8192
    s_mov_b64 exec, s[48:49]
    v_cmp_eq_u32 vcc, 0, v0
    s_nop 1
    v_cndmask_b32 v32, v32, 0, vcc
    s_nop 1
    v_cndmask_b32 v33, v33, 0, vcc
    s_nop 1
    v_cndmask_b32 v34, v34, 0, vcc
    s_nop 1
    v_cndmask_b32 v35, v35, 0, vcc
    v_alignbit_b32 v40, v33, v32, 16
    v_alignbit_b32 v41, v34, v33, 16
    v_alignbit_b32 v42, v35, v34, 16
    v_alignbit_b32 v43, v36, v35, 16
    ds_write_b128 v24, v[40:43] offset:9472
    v_mov_b32 v40, v33
    v_mov_b32 v41, v34
    v_mov_b32 v42, v35
    v_mov_b32 v43, v36
    ds_write_b128 v24, v[40:43] offset:13600
    v_alignbit_b32 v40, v34, v33, 16
    v_alignbit_b32 v41, v35, v34, 16
    v_alignbit_b32 v42, v36, v35, 16
    v_alignbit_b32 v43, v37, v36, 16
    ds_write_b128 v24, v[40:43] offset:17728
    v_mov_b32 v40, v34
    v_mov_b32 v41, v35
    v_mov_b32 v42, v36
    v_mov_b32 v43, v37
    ds_write_b128 v24, v[40:43] offset:21856
    v_alignbit_b32 v40, v35, v34, 16
    v_alignbit_b32 v41, v36, v35, 16
    v_alignbit_b32 v42, v37, v36, 16
    v_alignbit_b32 v43, v38, v37, 16
    ds_write_b128 v24, v[40:43] offset:25984
    v_mov_b32 v40, v35
    v_mov_b32 v41, v36
    v_mov_b32 v42, v37
    v_mov_b32 v43, v38
    ds_write_b128 v24, v[40:43] offset:30112
    v_alignbit_b32 v40, v36, v35, 16
    v_alignbit_b32 v41, v37, v36, 16
    v_alignbit_b32 v42, v38, v37, 16
    v_alignbit_b32 v43, v39, v38, 16
    ds_write_b128 v24, v[40:43] offset:34240
    v_mov_b32 v40, v36
    v_mov_b32 v41, v37
    v_mov_b32 v42, v38
    v_mov_b32 v43, v39
    ds_write_b128 v24, v[40:43] offset:38368
    s_waitcnt lgkmcnt(0)
    s_barrier
    v_sub_u32 v24, v4, v3
    v_lshlrev_b32 v24, 4, v24
    v_lshl_add_u32 v24, v2, 7, v24
    v_add_u32 v24, 4080, v24
    v_and_b32 v26, 7, v3
    v_mul_u32_u24 v26, 4128, v26
    v_lshrrev_b32 v27, 3, v3
    v_lshl_add_u32 v26, v27, 9, v26
    v_lshl_add_u32 v26, v4, 4, v26
    v_lshl_add_u32 v26, v2, 7, v26
    v_add_u32 v26, 9472, v26
    v_lshlrev_b32 v28, 4, v4
    v_lshl_add_u32 v28, v2, 7, v28
    v_add_u32 v28, 42496, v28
    v_mov_b32 v32, 0
    v_mov_b32 v33, 0
    v_mov_b32 v34, 0
    v_mov_b32 v35, 0
    v_mov_b32 v36, 0
    v_mov_b32 v37, 0
    v_mov_b32 v38, 0
    v_mov_b32 v39, 0
    v_mov_b32 v40, 0
    v_mov_b32 v41, 0
    v_mov_b32 v42, 0
    v_mov_b32 v43, 0
    v_mov_b32 v44, 0
    v_mov_b32 v45, 0
    v_mov_b32 v46, 0
    v_mov_b32 v47, 0
    v_mov_b32 v48, 0
    v_mov_b32 v49, 0
    v_mov_b32 v50, 0
    v_mov_b32 v51, 0
    v_mov_b32 v52, 0
    v_mov_b32 v53, 0
    v_mov_b32 v54, 0
    v_mov_b32 v55, 0
    v_mov_b32 v56, 0
    v_mov_b32 v57, 0
    v_mov_b32 v58, 0
    v_mov_b32 v59, 0
    v_mov_b32 v60, 0
    v_mov_b32 v61, 0
    v_mov_b32 v62, 0
    v_mov_b32 v63, 0
    v_subrev_u32 v29, 0, v24
    ds_read_b128 v[64:67], v29 offset:0
    ds_read_b128 v[80:83], v29 offset:4736
    ds_read_b128 v[68:71], v29 offset:32
    ds_read_b128 v[84:87], v29 offset:4768
    ds_read_b128 v[72:75], v29 offset:64
    ds_read_b128 v[88:91], v29 offset:4800
    ds_read_b128 v[76:79], v29 offset:96
    ds_read_b128 v[92:95], v29 offset:4832
    v_add_u32 v30, 0, v26
    v_add_u32 v31, 0, v27
    v_cmp_le_u32 vcc, 0, v31
    s_nop 1
    v_cndmask_b32 v30, v28, v30, vcc
    ds_read_b128 v[104:107], v30 offset:0
    ds_read_b128 v[108:111], v30 offset:32
    ds_read_b128 v[112:115], v30 offset:64
    ds_read_b128 v[116:119], v30 offset:96
    v_add_u32 v30, 2048, v26
    v_add_u32 v31, 4, v27
    v_cmp_le_u32 vcc, 0, v31
    s_nop 1
    v_cndmask_b32 v30, v28, v30, vcc
    ds_read_b128 v[120:123], v30 offset:0
    ds_read_b128 v[124:127], v30 offset:32
    ds_read_b128 v[128:131], v30 offset:64
    ds_read_b128 v[132:135], v30 offset:96
    s_waitcnt lgkmcnt(0)
    v_mfma_f32_32x32x16_bf16 v[32:47], v[64:67], v[104:107], v[32:47]
    v_mfma_f32_32x32x16_bf16 v[32:47], v[80:83], v[104:107], v[32:47]
    v_mfma_f32_32x32x16_bf16 v[32:47], v[68:71], v[108:111], v[32:47]
    v_mfma_f32_32x32x16_bf16 v[32:47], v[84:87], v[108:111], v[32:47]
    v_mfma_f32_32x32x16_bf16 v[32:47], v[72:75], v[112:115], v[32:47]
    v_mfma_f32_32x32x16_bf16 v[32:47], v[88:91], v[112:115], v[32:47]
    v_mfma_f32_32x32x16_bf16 v[32:47], v[76:79], v[116:119], v[32:47]
    v_mfma_f32_32x32x16_bf16 v[32:47], v[92:95], v[116:119], v[32:47]
    v_mfma_f32_32x32x16_bf16 v[48:63], v[64:67], v[120:123], v[48:63]
    v_mfma_f32_32x32x16_bf16 v[48:63], v[80:83], v[120:123], v[48:63]
    v_mfma_f32_32x32x16_bf16 v[48:63], v[68:71], v[124:127], v[48:63]
    v_mfma_f32_32x32x16_bf16 v[48:63], v[84:87], v[124:127], v[48:63]
    v_mfma_f32_32x32x16_bf16 v[48:63], v[72:75], v[128:131], v[48:63]
    v_mfma_f32_32x32x16_bf16 v[48:63], v[88:91], v[128:131], v[48:63]
    v_mfma_f32_32x32x16_bf16 v[48:63], v[76:79], v[132:135], v[48:63]
    v_mfma_f32_32x32x16_bf16 v[48:63], v[92:95], v[132:135], v[48:63]
    s_nop 7
    s_nop 7
    v_subrev_u32 v29, 512, v24
    ds_read_b128 v[64:67], v29 offset:0
    ds_read_b128 v[80:83], v29 offset:4736
    ds_read_b128 v[68:71], v29 offset:32
    ds_read_b128 v[84:87], v29 offset:4768
    ds_read_b128 v[72:75], v29 offset:64
    ds_read_b128 v[88:91], v29 offset:4800
    ds_read_b128 v[76:79], v29 offset:96
    ds_read_b128 v[92:95], v29 offset:4832
    v_add_u32 v30, -512, v26
    v_add_u32 v31, 0, v27
    v_cmp_le_u32 vcc, 1, v31
    s_nop 1
    v_cndmask_b32 v30, v28, v30, vcc
    ds_read_b128 v[104:107], v30 offset:0
    ds_read_b128 v[108:111], v30 offset:32
    ds_read_b128 v[112:115], v30 offset:64
    ds_read_b128 v[116:119], v30 offset:96
    v_add_u32 v30, 1536, v26
    v_add_u32 v31, 4, v27
    v_cmp_le_u32 vcc, 1, v31
    s_nop 1
    v_cndmask_b32 v30, v28, v30, vcc
    ds_read_b128 v[120:123], v30 offset:0
    ds_read_b128 v[124:127], v30 offset:32
    ds_read_b128 v[128:131], v30 offset:64
    ds_read_b128 v[132:135], v30 offset:96
    s_waitcnt lgkmcnt(0)
    v_mfma_f32_32x32x16_bf16 v[32:47], v[64:67], v[104:107], v[32:47]
    v_mfma_f32_32x32x16_bf16 v[32:47], v[80:83], v[104:107], v[32:47]
    v_mfma_f32_32x32x16_bf16 v[32:47], v[68:71], v[108:111], v[32:47]
    v_mfma_f32_32x32x16_bf16 v[32:47], v[84:87], v[108:111], v[32:47]
    v_mfma_f32_32x32x16_bf16 v[32:47], v[72:75], v[112:115], v[32:47]
    v_mfma_f32_32x32x16_bf16 v[32:47], v[88:91], v[112:115], v[32:47]
    v_mfma_f32_32x32x16_bf16 v[32:47], v[76:79], v[116:119], v[32:47]
    v_mfma_f32_32x32x16_bf16 v[32:47], v[92:95], v[116:119], v[32:47]
    v_mfma_f32_32x32x16_bf16 v[48:63], v[64:67], v[120:123], v[48:63]
    v_mfma_f32_32x32x16_bf16 v[48:63], v[80:83], v[120:123], v[48:63]
    v_mfma_f32_32x32x16_bf16 v[48:63], v[68:71], v[124:127], v[48:63]
    v_mfma_f32_32x32x16_bf16 v[48:63], v[84:87], v[124:127], v[48:63]
    v_mfma_f32_32x32x16_bf16 v[48:63], v[72:75], v[128:131], v[48:63]
    v_mfma_f32_32x32x16_bf16 v[48:63], v[88:91], v[128:131], v[48:63]
    v_mfma_f32_32x32x16_bf16 v[48:63], v[76:79], v[132:135], v[48:63]
    v_mfma_f32_32x32x16_bf16 v[48:63], v[92:95], v[132:135], v[48:63]
    s_nop 7
    s_nop 7
    v_subrev_u32 v29, 1024, v24
    ds_read_b128 v[64:67], v29 offset:0
    ds_read_b128 v[80:83], v29 offset:4736
    ds_read_b128 v[68:71], v29 offset:32
    ds_read_b128 v[84:87], v29 offset:4768
    ds_read_b128 v[72:75], v29 offset:64
    ds_read_b128 v[88:91], v29 offset:4800
    ds_read_b128 v[76:79], v29 offset:96
    ds_read_b128 v[92:95], v29 offset:4832
    v_add_u32 v30, -1024, v26
    v_add_u32 v31, 0, v27
    v_cmp_le_u32 vcc, 2, v31
    s_nop 1
    v_cndmask_b32 v30, v28, v30, vcc
    ds_read_b128 v[104:107], v30 offset:0
    ds_read_b128 v[108:111], v30 offset:32
    ds_read_b128 v[112:115], v30 offset:64
    ds_read_b128 v[116:119], v30 offset:96
    v_add_u32 v30, 1024, v26
    v_add_u32 v31, 4, v27
    v_cmp_le_u32 vcc, 2, v31
    s_nop 1
    v_cndmask_b32 v30, v28, v30, vcc
    ds_read_b128 v[120:123], v30 offset:0
    ds_read_b128 v[124:127], v30 offset:32
    ds_read_b128 v[128:131], v30 offset:64
    ds_read_b128 v[132:135], v30 offset:96
    s_waitcnt lgkmcnt(0)
    v_mfma_f32_32x32x16_bf16 v[32:47], v[64:67], v[104:107], v[32:47]
    v_mfma_f32_32x32x16_bf16 v[32:47], v[80:83], v[104:107], v[32:47]
    v_mfma_f32_32x32x16_bf16 v[32:47], v[68:71], v[108:111], v[32:47]
    v_mfma_f32_32x32x16_bf16 v[32:47], v[84:87], v[108:111], v[32:47]
    v_mfma_f32_32x32x16_bf16 v[32:47], v[72:75], v[112:115], v[32:47]
    v_mfma_f32_32x32x16_bf16 v[32:47], v[88:91], v[112:115], v[32:47]
    v_mfma_f32_32x32x16_bf16 v[32:47], v[76:79], v[116:119], v[32:47]
    v_mfma_f32_32x32x16_bf16 v[32:47], v[92:95], v[116:119], v[32:47]
    v_mfma_f32_32x32x16_bf16 v[48:63], v[64:67], v[120:123], v[48:63]
    v_mfma_f32_32x32x16_bf16 v[48:63], v[80:83], v[120:123], v[48:63]
    v_mfma_f32_32x32x16_bf16 v[48:63], v[68:71], v[124:127], v[48:63]
    v_mfma_f32_32x32x16_bf16 v[48:63], v[84:87], v[124:127], v[48:63]
    v_mfma_f32_32x32x16_bf16 v[48:63], v[72:75], v[128:131], v[48:63]
    v_mfma_f32_32x32x16_bf16 v[48:63], v[88:91], v[128:131], v[48:63]
    v_mfma_f32_32x32x16_bf16 v[48:63], v[76:79], v[132:135], v[48:63]
    v_mfma_f32_32x32x16_bf16 v[48:63], v[92:95], v[132:135], v[48:63]
    s_nop 7
    s_nop 7
    v_subrev_u32 v29, 1536, v24
    ds_read_b128 v[64:67], v29 offset:0
    ds_read_b128 v[80:83], v29 offset:4736
    ds_read_b128 v[68:71], v29 offset:32
    ds_read_b128 v[84:87], v29 offset:4768
    ds_read_b128 v[72:75], v29 offset:64
    ds_read_b128 v[88:91], v29 offset:4800
    ds_read_b128 v[76:79], v29 offset:96
    ds_read_b128 v[92:95], v29 offset:4832
    v_add_u32 v30, -1536, v26
    v_add_u32 v31, 0, v27
    v_cmp_le_u32 vcc, 3, v31
    s_nop 1
    v_cndmask_b32 v30, v28, v30, vcc
    ds_read_b128 v[104:107], v30 offset:0
    ds_read_b128 v[108:111], v30 offset:32
    ds_read_b128 v[112:115], v30 offset:64
    ds_read_b128 v[116:119], v30 offset:96
    v_add_u32 v30, 512, v26
    v_add_u32 v31, 4, v27
    v_cmp_le_u32 vcc, 3, v31
    s_nop 1
    v_cndmask_b32 v30, v28, v30, vcc
    ds_read_b128 v[120:123], v30 offset:0
    ds_read_b128 v[124:127], v30 offset:32
    ds_read_b128 v[128:131], v30 offset:64
    ds_read_b128 v[132:135], v30 offset:96
    s_waitcnt lgkmcnt(0)
    v_mfma_f32_32x32x16_bf16 v[32:47], v[64:67], v[104:107], v[32:47]
    v_mfma_f32_32x32x16_bf16 v[32:47], v[80:83], v[104:107], v[32:47]
    v_mfma_f32_32x32x16_bf16 v[32:47], v[68:71], v[108:111], v[32:47]
    v_mfma_f32_32x32x16_bf16 v[32:47], v[84:87], v[108:111], v[32:47]
    v_mfma_f32_32x32x16_bf16 v[32:47], v[72:75], v[112:115], v[32:47]
    v_mfma_f32_32x32x16_bf16 v[32:47], v[88:91], v[112:115], v[32:47]
    v_mfma_f32_32x32x16_bf16 v[32:47], v[76:79], v[116:119], v[32:47]
    v_mfma_f32_32x32x16_bf16 v[32:47], v[92:95], v[116:119], v[32:47]
    v_mfma_f32_32x32x16_bf16 v[48:63], v[64:67], v[120:123], v[48:63]
    v_mfma_f32_32x32x16_bf16 v[48:63], v[80:83], v[120:123], v[48:63]
    v_mfma_f32_32x32x16_bf16 v[48:63], v[68:71], v[124:127], v[48:63]
    v_mfma_f32_32x32x16_bf16 v[48:63], v[84:87], v[124:127], v[48:63]
    v_mfma_f32_32x32x16_bf16 v[48:63], v[72:75], v[128:131], v[48:63]
    v_mfma_f32_32x32x16_bf16 v[48:63], v[88:91], v[128:131], v[48:63]
    v_mfma_f32_32x32x16_bf16 v[48:63], v[76:79], v[132:135], v[48:63]
    v_mfma_f32_32x32x16_bf16 v[48:63], v[92:95], v[132:135], v[48:63]
    s_nop 7
    s_nop 7
    v_subrev_u32 v29, 2048, v24
    ds_read_b128 v[64:67], v29 offset:0
    ds_read_b128 v[80:83], v29 offset:4736
    ds_read_b128 v[68:71], v29 offset:32
    ds_read_b128 v[84:87], v29 offset:4768
    ds_read_b128 v[72:75], v29 offset:64
    ds_read_b128 v[88:91], v29 offset:4800
    ds_read_b128 v[76:79], v29 offset:96
    ds_read_b128 v[92:95], v29 offset:4832
    v_add_u32 v30, 0, v26
    v_add_u32 v31, 4, v27
    v_cmp_le_u32 vcc, 4, v31
    s_nop 1
    v_cndmask_b32 v30, v28, v30, vcc
    ds_read_b128 v[120:123], v30 offset:0
    ds_read_b128 v[124:127], v30 offset:32
    ds_read_b128 v[128:131], v30 offset:64
    ds_read_b128 v[132:135], v30 offset:96
    s_waitcnt lgkmcnt(0)
    v_mfma_f32_32x32x16_bf16 v[48:63], v[64:67], v[120:123], v[48:63]
    v_mfma_f32_32x32x16_bf16 v[48:63], v[80:83], v[120:123], v[48:63]
    v_mfma_f32_32x32x16_bf16 v[48:63], v[68:71], v[124:127], v[48:63]
    v_mfma_f32_32x32x16_bf16 v[48:63], v[84:87], v[124:127], v[48:63]
    v_mfma_f32_32x32x16_bf16 v[48:63], v[72:75], v[128:131], v[48:63]
    v_mfma_f32_32x32x16_bf16 v[48:63], v[88:91], v[128:131], v[48:63]
    v_mfma_f32_32x32x16_bf16 v[48:63], v[76:79], v[132:135], v[48:63]
    v_mfma_f32_32x32x16_bf16 v[48:63], v[92:95], v[132:135], v[48:63]
    s_nop 7
    s_nop 7
    v_subrev_u32 v29, 2560, v24
    ds_read_b128 v[64:67], v29 offset:0
    ds_read_b128 v[80:83], v29 offset:4736
    ds_read_b128 v[68:71], v29 offset:32
    ds_read_b128 v[84:87], v29 offset:4768
    ds_read_b128 v[72:75], v29 offset:64
    ds_read_b128 v[88:91], v29 offset:4800
    ds_read_b128 v[76:79], v29 offset:96
    ds_read_b128 v[92:95], v29 offset:4832
    v_add_u32 v30, -512, v26
    v_add_u32 v31, 4, v27
    v_cmp_le_u32 vcc, 5, v31
    s_nop 1
    v_cndmask_b32 v30, v28, v30, vcc
    ds_read_b128 v[120:123], v30 offset:0
    ds_read_b128 v[124:127], v30 offset:32
    ds_read_b128 v[128:131], v30 offset:64
    ds_read_b128 v[132:135], v30 offset:96
    s_waitcnt lgkmcnt(0)
    v_mfma_f32_32x32x16_bf16 v[48:63], v[64:67], v[120:123], v[48:63]
    v_mfma_f32_32x32x16_bf16 v[48:63], v[80:83], v[120:123], v[48:63]
    v_mfma_f32_32x32x16_bf16 v[48:63], v[68:71], v[124:127], v[48:63]
    v_mfma_f32_32x32x16_bf16 v[48:63], v[84:87], v[124:127], v[48:63]
    v_mfma_f32_32x32x16_bf16 v[48:63], v[72:75], v[128:131], v[48:63]
    v_mfma_f32_32x32x16_bf16 v[48:63], v[88:91], v[128:131], v[48:63]
    v_mfma_f32_32x32x16_bf16 v[48:63], v[76:79], v[132:135], v[48:63]
    v_mfma_f32_32x32x16_bf16 v[48:63], v[92:95], v[132:135], v[48:63]
    s_nop 7
    s_nop 7
    v_subrev_u32 v29, 3072, v24
    ds_read_b128 v[64:67], v29 offset:0
    ds_read_b128 v[80:83], v29 offset:4736
    ds_read_b128 v[68:71], v29 offset:32
    ds_read_b128 v[84:87], v29 offset:4768
    ds_read_b128 v[72:75], v29 offset:64
    ds_read_b128 v[88:91], v29 offset:4800
    ds_read_b128 v[76:79], v29 offset:96
    ds_read_b128 v[92:95], v29 offset:4832
    v_add_u32 v30, -1024, v26
    v_add_u32 v31, 4, v27
    v_cmp_le_u32 vcc, 6, v31
    s_nop 1
    v_cndmask_b32 v30, v28, v30, vcc
    ds_read_b128 v[120:123], v30 offset:0
    ds_read_b128 v[124:127], v30 offset:32
    ds_read_b128 v[128:131], v30 offset:64
    ds_read_b128 v[132:135], v30 offset:96
    s_waitcnt lgkmcnt(0)
    v_mfma_f32_32x32x16_bf16 v[48:63], v[64:67], v[120:123], v[48:63]
    v_mfma_f32_32x32x16_bf16 v[48:63], v[80:83], v[120:123], v[48:63]
    v_mfma_f32_32x32x16_bf16 v[48:63], v[68:71], v[124:127], v[48:63]
    v_mfma_f32_32x32x16_bf16 v[48:63], v[84:87], v[124:127], v[48:63]
    v_mfma_f32_32x32x16_bf16 v[48:63], v[72:75], v[128:131], v[48:63]
    v_mfma_f32_32x32x16_bf16 v[48:63], v[88:91], v[128:131], v[48:63]
    v_mfma_f32_32x32x16_bf16 v[48:63], v[76:79], v[132:135], v[48:63]
    v_mfma_f32_32x32x16_bf16 v[48:63], v[92:95], v[132:135], v[48:63]
    s_nop 7
    s_nop 7
    v_subrev_u32 v29, 3584, v24
    ds_read_b128 v[64:67], v29 offset:0
    ds_read_b128 v[80:83], v29 offset:4736
    ds_read_b128 v[68:71], v29 offset:32
    ds_read_b128 v[84:87], v29 offset:4768
    ds_read_b128 v[72:75], v29 offset:64
    ds_read_b128 v[88:91], v29 offset:4800
    ds_read_b128 v[76:79], v29 offset:96
    ds_read_b128 v[92:95], v29 offset:4832
    v_add_u32 v30, -1536, v26
    v_add_u32 v31, 4, v27
    v_cmp_le_u32 vcc, 7, v31
    s_nop 1
    v_cndmask_b32 v30, v28, v30, vcc
    ds_read_b128 v[120:123], v30 offset:0
    ds_read_b128 v[124:127], v30 offset:32
    ds_read_b128 v[128:131], v30 offset:64
    ds_read_b128 v[132:135], v30 offset:96
    s_waitcnt lgkmcnt(0)
    v_mfma_f32_32x32x16_bf16 v[48:63], v[64:67], v[120:123], v[48:63]
    v_mfma_f32_32x32x16_bf16 v[48:63], v[80:83], v[120:123], v[48:63]
    v_mfma_f32_32x32x16_bf16 v[48:63], v[68:71], v[124:127], v[48:63]
    v_mfma_f32_32x32x16_bf16 v[48:63], v[84:87], v[124:127], v[48:63]
    v_mfma_f32_32x32x16_bf16 v[48:63], v[72:75], v[128:131], v[48:63]
    v_mfma_f32_32x32x16_bf16 v[48:63], v[88:91], v[128:131], v[48:63]
    v_mfma_f32_32x32x16_bf16 v[48:63], v[76:79], v[132:135], v[48:63]
    v_mfma_f32_32x32x16_bf16 v[48:63], v[92:95], v[132:135], v[48:63]
    s_nop 7
    s_nop 7
    s_nop 15
    s_barrier
    v_and_b32 v29, 7, v3
    v_lshlrev_b32 v29, 2, v29
    v_lshl_add_u32 v29, v27, 10, v29
    v_lshl_add_u32 v29, v4, 7, v29
    v_lshl_add_u32 v29, v2, 13, v29
    ds_write_b32 v29, v32 offset:9472
    ds_write_b32 v29, v33 offset:9504
    ds_write_b32 v29, v34 offset:9536
    ds_write_b32 v29, v35 offset:9568
    ds_write_b32 v29, v36 offset:9728
    ds_write_b32 v29, v37 offset:9760
    ds_write_b32 v29, v38 offset:9792
    ds_write_b32 v29, v39 offset:9824
    ds_write_b32 v29, v40 offset:9984
    ds_write_b32 v29, v41 offset:10016
    ds_write_b32 v29, v42 offset:10048
    ds_write_b32 v29, v43 offset:10080
    ds_write_b32 v29, v44 offset:10240
    ds_write_b32 v29, v45 offset:10272
    ds_write_b32 v29, v46 offset:10304
    ds_write_b32 v29, v47 offset:10336
    ds_write_b32 v29, v48 offset:13568
    ds_write_b32 v29, v49 offset:13600
    ds_write_b32 v29, v50 offset:13632
    ds_write_b32 v29, v51 offset:13664
    ds_write_b32 v29, v52 offset:13824
    ds_write_b32 v29, v53 offset:13856
    ds_write_b32 v29, v54 offset:13888
    ds_write_b32 v29, v55 offset:13920
    ds_write_b32 v29, v56 offset:14080
    ds_write_b32 v29, v57 offset:14112
    ds_write_b32 v29, v58 offset:14144
    ds_write_b32 v29, v59 offset:14176
    ds_write_b32 v29, v60 offset:14336
    ds_write_b32 v29, v61 offset:14368
    ds_write_b32 v29, v62 offset:14400
    ds_write_b32 v29, v63 offset:14432
    s_waitcnt lgkmcnt(0)
    s_barrier
    v_lshlrev_b32 v24, 5, v0
    ds_read_b128 v[32:35], v24 offset:9472
    ds_read_b128 v[36:39], v24 offset:9488
    ds_read_b128 v[40:43], v24 offset:17664
    ds_read_b128 v[44:47], v24 offset:17680
    ds_read_b128 v[48:51], v24 offset:25856
    ds_read_b128 v[52:55], v24 offset:25872
    ds_read_b128 v[56:59], v24 offset:34048
    ds_read_b128 v[60:63], v24 offset:34064
    v_lshlrev_b32 v24, 4, v0
    s_waitcnt lgkmcnt(0)
    v_add_f32 v32, v32, v40
    v_add_f32 v48, v48, v56
    v_add_f32 v32, v32, v48
    v_add_f32 v33, v33, v41
    v_add_f32 v49, v49, v57
    v_add_f32 v33, v33, v49
    v_add_f32 v34, v34, v42
    v_add_f32 v50, v50, v58
    v_add_f32 v34, v34, v50
    v_add_f32 v35, v35, v43
    v_add_f32 v51, v51, v59
    v_add_f32 v35, v35, v51
    v_add_f32 v36, v36, v44
    v_add_f32 v52, v52, v60
    v_add_f32 v36, v36, v52
    v_add_f32 v37, v37, v45
    v_add_f32 v53, v53, v61
    v_add_f32 v37, v37, v53
    v_add_f32 v38, v38, v46
    v_add_f32 v54, v54, v62
    v_add_f32 v38, v38, v54
    v_add_f32 v39, v39, v47
    v_add_f32 v55, v55, v63
    v_add_f32 v39, v39, v55
    v_cvt_pk_bf16_f32 v64, v32, v33
    v_cvt_pk_bf16_f32 v65, v34, v35
    v_cvt_pk_bf16_f32 v66, v36, v37
    v_cvt_pk_bf16_f32 v67, v38, v39
    s_add_u32 s31, s30, 8388608
    buffer_store_dwordx4 v[64:67], v140, s[44:47], s31 offen
conv_end:
    s_endpgm
.globl ln2_kernel
.p2align 8
.type ln2_kernel,@function
ln2_kernel:
    s_cmp_ge_u32 s2, 256
    s_cbranch_scc1 ln2_end
    s_load_dwordx2 s[4:5], s[0:1], 0
    s_load_dwordx2 s[6:7], s[0:1], 104
    s_load_dwordx2 s[20:21], s[0:1], 48
    s_waitcnt lgkmcnt(0)
    s_mov_b32 s8, s4
    s_mov_b32 s9, s5
    s_mov_b32 s10, 2621440
    s_mov_b32 s11, 0x00020000
    s_mov_b32 s12, s6
    s_mov_b32 s13, s7
    s_mov_b32 s14, 67108864
    s_mov_b32 s15, 0x00020000
    s_mov_b32 s24, s20
    s_mov_b32 s25, s21
    s_mov_b32 s26, 1280
    s_mov_b32 s27, 0x00020000
    v_and_b32 v1, 63, v0
    v_lshrrev_b32 v2, 6, v0
    v_xor_b32 v4, 1, v1
    v_lshlrev_b32 v4, 2, v4
    v_xor_b32 v5, 2, v1
    v_lshlrev_b32 v5, 2, v5
    v_xor_b32 v6, 4, v1
    v_lshlrev_b32 v6, 2, v6
    v_xor_b32 v7, 8, v1
    v_lshlrev_b32 v7, 2, v7
    v_xor_b32 v8, 16, v1
    v_lshlrev_b32 v8, 2, v8
    v_xor_b32 v9, 32, v1
    v_lshlrev_b32 v9, 2, v9
    s_mul_i32 s16, s2, 10240
    v_mul_u32_u24 v3, 2560, v2
    v_lshl_add_u32 v3, v1, 2, v3
    v_lshlrev_b32 v11, 2, v1
    s_add_u32 s17, s16, 0
    buffer_load_dword v16, v3, s[8:11], s17 offen offset:0
    buffer_load_dword v17, v3, s[8:11], s17 offen offset:256
    buffer_load_dword v18, v3, s[8:11], s17 offen offset:512
    buffer_load_dword v19, v3, s[8:11], s17 offen offset:768
    buffer_load_dword v20, v3, s[8:11], s17 offen offset:1024
    s_add_u32 s17, s16, 1280
    buffer_load_dword v21, v3, s[8:11], s17 offen offset:0
    buffer_load_dword v22, v3, s[8:11], s17 offen offset:256
    buffer_load_dword v23, v3, s[8:11], s17 offen offset:512
    buffer_load_dword v24, v3, s[8:11], s17 offen offset:768
    buffer_load_dword v25, v3, s[8:11], s17 offen offset:1024
    buffer_load_dword v160, v11, s[24:27], 0 offen offset:0
    buffer_load_dword v161, v11, s[24:27], 0 offen offset:256
    buffer_load_dword v162, v11, s[24:27], 0 offen offset:512
    buffer_load_dword v163, v11, s[24:27], 0 offen offset:768
    buffer_load_dword v164, v11, s[24:27], 0 offen offset:1024
    v_lshlrev_b32 v10, 7, v1
    v_lshl_add_u32 v10, v2, 2, v10
    s_lshr_b32 s17, s2, 2
    s_mul_i32 s17, s17, 40960
    s_and_b32 s18, s2, 3
    s_lshl_b32 s18, s18, 4
    s_add_u32 s17, s17, s18
    s_add_u32 s17, s17, 8388608
    buffer_load_dword v166, v10, s[12:15], s17 offen
    buffer_load_dword v168, v10, s[12:15], s17 offen offset:64
    s_add_u32 s17, s17, 8192
    buffer_load_dword v170, v10, s[12:15], s17 offen
    buffer_load_dword v172, v10, s[12:15], s17 offen offset:64
    s_add_u32 s17, s17, 8192
    buffer_load_dword v174, v10, s[12:15], s17 offen
    buffer_load_dword v176, v10, s[12:15], s17 offen offset:64
    s_add_u32 s17, s17, 8192
    buffer_load_dword v178, v10, s[12:15], s17 offen
    buffer_load_dword v180, v10, s[12:15], s17 offen offset:64
    s_add_u32 s17, s17, 8192
    buffer_load_dword v182, v10, s[12:15], s17 offen
    buffer_load_dword v184, v10, s[12:15], s17 offen offset:64
    s_add_u32 s17, s17, 8192
    s_waitcnt vmcnt(0)
    v_mov_b32 v56, 0
    v_lshlrev_b32 v72, 16, v16
    v_and_b32 v73, 0xffff0000, v16
    v_add_f32 v56, v56, v72
    v_add_f32 v56, v56, v73
    v_lshlrev_b32 v72, 16, v17
    v_and_b32 v73, 0xffff0000, v17
    v_add_f32 v56, v56, v72
    v_add_f32 v56, v56, v73
    v_lshlrev_b32 v72, 16, v18
    v_and_b32 v73, 0xffff0000, v18
    v_add_f32 v56, v56, v72
    v_add_f32 v56, v56, v73
    v_lshlrev_b32 v72, 16, v19
    v_and_b32 v73, 0xffff0000, v19
    v_add_f32 v56, v56, v72
    v_add_f32 v56, v56, v73
    v_lshlrev_b32 v72, 16, v20
    v_and_b32 v73, 0xffff0000, v20
    v_add_f32 v56, v56, v72
    v_add_f32 v56, v56, v73
    v_mov_b32 v57, 0
    v_lshlrev_b32 v72, 16, v21
    v_and_b32 v73, 0xffff0000, v21
    v_add_f32 v57, v57, v72
    v_add_f32 v57, v57, v73
    v_lshlrev_b32 v72, 16, v22
    v_and_b32 v73, 0xffff0000, v22
    v_add_f32 v57, v57, v72
    v_add_f32 v57, v57, v73
    v_lshlrev_b32 v72, 16, v23
    v_and_b32 v73, 0xffff0000, v23
    v_add_f32 v57, v57, v72
    v_add_f32 v57, v57, v73
    v_lshlrev_b32 v72, 16, v24
    v_and_b32 v73, 0xffff0000, v24
    v_add_f32 v57, v57, v72
    v_add_f32 v57, v57, v73
    v_lshlrev_b32 v72, 16, v25
    v_and_b32 v73, 0xffff0000, v25
    v_add_f32 v57, v57, v72
    v_add_f32 v57, v57, v73
    s_nop 1
    v_add_f32_dpp v56, v56, v56 row_shr:1 row_mask:0xf bank_mask:0xf bound_ctrl:0
    v_add_f32_dpp v57, v57, v57 row_shr:1 row_mask:0xf bank_mask:0xf bound_ctrl:0
    s_nop 1
    v_add_f32_dpp v56, v56, v56 row_shr:2 row_mask:0xf bank_mask:0xf bound_ctrl:0
    v_add_f32_dpp v57, v57, v57 row_shr:2 row_mask:0xf bank_mask:0xf bound_ctrl:0
    s_nop 1
    v_add_f32_dpp v56, v56, v56 row_shr:4 row_mask:0xf bank_mask:0xf bound_ctrl:0
    v_add_f32_dpp v57, v57, v57 row_shr:4 row_mask:0xf bank_mask:0xf bound_ctrl:0
    s_nop 1
    v_add_f32_dpp v56, v56, v56 row_shr:8 row_mask:0xf bank_mask:0xf bound_ctrl:0
    v_add_f32_dpp v57, v57, v57 row_shr:8 row_mask:0xf bank_mask:0xf bound_ctrl:0
    s_nop 1
    v_add_f32_dpp v56, v56, v56 row_bcast:15 row_mask:0xa bank_mask:0xf
    v_add_f32_dpp v57, v57, v57 row_bcast:15 row_mask:0xa bank_mask:0xf
    s_nop 1
    v_add_f32_dpp v56, v56, v56 row_bcast:31 row_mask:0xc bank_mask:0xf
    v_add_f32_dpp v57, v57, v57 row_bcast:31 row_mask:0xc bank_mask:0xf
    s_nop 1
    v_readlane_b32 s70, v56, 63
    v_readlane_b32 s71, v57, 63
    s_nop 1
    v_mov_b32 v56, s70
    v_mov_b32 v57, s71
    v_mul_f32 v76, 0x3acccccd, v56
    v_mov_b32 v56, 0
    v_lshlrev_b32 v72, 16, v16
    v_and_b32 v73, 0xffff0000, v16
    v_sub_f32 v72, v72, v76
    v_sub_f32 v73, v73, v76
    v_fmac_f32 v56, v72, v72
    v_fmac_f32 v56, v73, v73
    v_lshlrev_b32 v72, 16, v17
    v_and_b32 v73, 0xffff0000, v17
    v_sub_f32 v72, v72, v76
    v_sub_f32 v73, v73, v76
    v_fmac_f32 v56, v72, v72
    v_fmac_f32 v56, v73, v73
    v_lshlrev_b32 v72, 16, v18
    v_and_b32 v73, 0xffff0000, v18
    v_sub_f32 v72, v72, v76
    v_sub_f32 v73, v73, v76
    v_fmac_f32 v56, v72, v72
    v_fmac_f32 v56, v73, v73
    v_lshlrev_b32 v72, 16, v19
    v_and_b32 v73, 0xffff0000, v19
    v_sub_f32 v72, v72, v76
    v_sub_f32 v73, v73, v76
    v_fmac_f32 v56, v72, v72
    v_fmac_f32 v56, v73, v73
    v_lshlrev_b32 v72, 16, v20
    v_and_b32 v73, 0xffff0000, v20
    v_sub_f32 v72, v72, v76
    v_sub_f32 v73, v73, v76
    v_fmac_f32 v56, v72, v72
    v_fmac_f32 v56, v73, v73
    v_mul_f32 v77, 0x3acccccd, v57
    v_mov_b32 v57, 0
    v_lshlrev_b32 v72, 16, v21
    v_and_b32 v73, 0xffff0000, v21
    v_sub_f32 v72, v72, v77
    v_sub_f32 v73, v73, v77
    v_fmac_f32 v57, v72, v72
    v_fmac_f32 v57, v73, v73
    v_lshlrev_b32 v72, 16, v22
    v_and_b32 v73, 0xffff0000, v22
    v_sub_f32 v72, v72, v77
    v_sub_f32 v73, v73, v77
    v_fmac_f32 v57, v72, v72
    v_fmac_f32 v57, v73, v73
    v_lshlrev_b32 v72, 16, v23
    v_and_b32 v73, 0xffff0000, v23
    v_sub_f32 v72, v72, v77
    v_sub_f32 v73, v73, v77
    v_fmac_f32 v57, v72, v72
    v_fmac_f32 v57, v73, v73
    v_lshlrev_b32 v72, 16, v24
    v_and_b32 v73, 0xffff0000, v24
    v_sub_f32 v72, v72, v77
    v_sub_f32 v73, v73, v77
    v_fmac_f32 v57, v72, v72
    v_fmac_f32 v57, v73, v73
    v_lshlrev_b32 v72, 16, v25
    v_and_b32 v73, 0xffff0000, v25
    v_sub_f32 v72, v72, v77
    v_sub_f32 v73, v73, v77
    v_fmac_f32 v57, v72, v72
    v_fmac_f32 v57, v73, v73
    s_nop 1
    v_add_f32_dpp v56, v56, v56 row_shr:1 row_mask:0xf bank_mask:0xf bound_ctrl:0
    v_add_f32_dpp v57, v57, v57 row_shr:1 row_mask:0xf bank_mask:0xf bound_ctrl:0
    s_nop 1
    v_add_f32_dpp v56, v56, v56 row_shr:2 row_mask:0xf bank_mask:0xf bound_ctrl:0
    v_add_f32_dpp v57, v57, v57 row_shr:2 row_mask:0xf bank_mask:0xf bound_ctrl:0
    s_nop 1
    v_add_f32_dpp v56, v56, v56 row_shr:4 row_mask:0xf bank_mask:0xf bound_ctrl:0
    v_add_f32_dpp v57, v57, v57 row_shr:4 row_mask:0xf bank_mask:0xf bound_ctrl:0
    s_nop 1
    v_add_f32_dpp v56, v56, v56 row_shr:8 row_mask:0xf bank_mask:0xf bound_ctrl:0
    v_add_f32_dpp v57, v57, v57 row_shr:8 row_mask:0xf bank_mask:0xf bound_ctrl:0
    s_nop 1
    v_add_f32_dpp v56, v56, v56 row_bcast:15 row_mask:0xa bank_mask:0xf
    v_add_f32_dpp v57, v57, v57 row_bcast:15 row_mask:0xa bank_mask:0xf
    s_nop 1
    v_add_f32_dpp v56, v56, v56 row_bcast:31 row_mask:0xc bank_mask:0xf
    v_add_f32_dpp v57, v57, v57 row_bcast:31 row_mask:0xc bank_mask:0xf
    s_nop 1
    v_readlane_b32 s70, v56, 63
    v_readlane_b32 s71, v57, 63
    s_nop 1
    v_mov_b32 v56, s70
    v_mov_b32 v57, s71
    v_mul_f32 v72, 0x3acccccd, v56
    v_cvt_pk_bf16_f32 v72, v72, v72
    v_lshlrev_b32 v72, 16, v72
    v_add_f32 v72, 0x3727c5ac, v72
    v_cvt_pk_bf16_f32 v72, v72, v72
    v_lshlrev_b32 v72, 16, v72
    v_sqrt_f32 v72, v72
    s_nop 0
    v_cvt_pk_bf16_f32 v84, v72, v72
    v_lshlrev_b32 v84, 16, v84
    v_rcp_f32 v92, v84
    v_cvt_pk_bf16_f32 v76, v76, v76
    v_lshlrev_b32 v76, 16, v76
    v_mul_f32 v72, 0x3acccccd, v57
    v_cvt_pk_bf16_f32 v72, v72, v72
    v_lshlrev_b32 v72, 16, v72
    v_add_f32 v72, 0x3727c5ac, v72
    v_cvt_pk_bf16_f32 v72, v72, v72
    v_lshlrev_b32 v72, 16, v72
    v_sqrt_f32 v72, v72
    s_nop 0
    v_cvt_pk_bf16_f32 v85, v72, v72
    v_lshlrev_b32 v85, 16, v85
    v_rcp_f32 v93, v85
    v_cvt_pk_bf16_f32 v77, v77, v77
    v_lshlrev_b32 v77, 16, v77
    v_lshlrev_b32 v72, 16, v16
    v_and_b32 v73, 0xffff0000, v16
    v_sub_f32 v72, v72, v76
    v_sub_f32 v73, v73, v76
    v_cvt_pk_bf16_f32 v74, v72, v73
    v_lshlrev_b32 v72, 16, v74
    v_and_b32 v73, 0xffff0000, v74
    v_mul_f32 v74, v72, v92
    v_fma_f32 v75, -v74, v84, v72
    v_fma_f32 v72, v75, v92, v74
    v_mul_f32 v74, v73, v92
    v_fma_f32 v75, -v74, v84, v73
    v_fma_f32 v73, v75, v92, v74
    v_cvt_pk_bf16_f32 v144, v72, v73
    v_lshlrev_b32 v72, 16, v21
    v_and_b32 v73, 0xffff0000, v21
    v_sub_f32 v72, v72, v77
    v_sub_f32 v73, v73, v77
    v_cvt_pk_bf16_f32 v74, v72, v73
    v_lshlrev_b32 v72, 16, v74
    v_and_b32 v73, 0xffff0000, v74
    v_mul_f32 v74, v72, v93
    v_fma_f32 v75, -v74, v85, v72
    v_fma_f32 v72, v75, v93, v74
    v_mul_f32 v74, v73, v93
    v_fma_f32 v75, -v74, v85, v73
    v_fma_f32 v73, v75, v93, v74
    v_cvt_pk_bf16_f32 v145, v72, v73
    v_lshlrev_b32 v12, 16, v160
    v_and_b32 v13, 0xffff0000, v160
    s_waitcnt vmcnt(0)
    v_lshlrev_b32 v72, 16, v144
    v_lshlrev_b32 v73, 16, v16
    v_lshlrev_b32 v74, 16, v166
    v_mul_f32 v72, v72, v12
    v_cvt_pk_bf16_f32 v72, v72, v72
    v_lshlrev_b32 v72, 16, v72
    v_add_f32 v72, v72, v74
    v_cvt_pk_bf16_f32 v72, v72, v72
    v_lshlrev_b32 v72, 16, v72
    v_add_f32 v14, v73, v72
    v_and_b32 v72, 0xffff0000, v144
    v_and_b32 v73, 0xffff0000, v16
    v_lshlrev_b32 v74, 16, v168
    v_mul_f32 v72, v72, v13
    v_cvt_pk_bf16_f32 v72, v72, v72
    v_lshlrev_b32 v72, 16, v72
    v_add_f32 v72, v72, v74
    v_cvt_pk_bf16_f32 v72, v72, v72
    v_lshlrev_b32 v72, 16, v72
    v_add_f32 v15, v73, v72
    v_cvt_pk_bf16_f32 v104, v14, v15
    v_lshlrev_b32 v72, 16, v145
    v_lshlrev_b32 v73, 16, v21
    v_and_b32 v74, 0xffff0000, v166
    v_mul_f32 v72, v72, v12
    v_cvt_pk_bf16_f32 v72, v72, v72
    v_lshlrev_b32 v72, 16, v72
    v_add_f32 v72, v72, v74
    v_cvt_pk_bf16_f32 v72, v72, v72
    v_lshlrev_b32 v72, 16, v72
    v_add_f32 v14, v73, v72
    v_and_b32 v72, 0xffff0000, v145
    v_and_b32 v73, 0xffff0000, v21
    v_and_b32 v74, 0xffff0000, v168
    v_mul_f32 v72, v72, v13
    v_cvt_pk_bf16_f32 v72, v72, v72
    v_lshlrev_b32 v72, 16, v72
    v_add_f32 v72, v72, v74
    v_cvt_pk_bf16_f32 v72, v72, v72
    v_lshlrev_b32 v72, 16, v72
    v_add_f32 v15, v73, v72
    v_cvt_pk_bf16_f32 v109, v14, v15
    v_lshlrev_b32 v72, 16, v17
    v_and_b32 v73, 0xffff0000, v17
    v_sub_f32 v72, v72, v76
    v_sub_f32 v73, v73, v76
    v_cvt_pk_bf16_f32 v74, v72, v73
    v_lshlrev_b32 v72, 16, v74
    v_and_b32 v73, 0xffff0000, v74
    v_mul_f32 v74, v72, v92
    v_fma_f32 v75, -v74, v84, v72
    v_fma_f32 v72, v75, v92, v74
    v_mul_f32 v74, v73, v92
    v_fma_f32 v75, -v74, v84, v73
    v_fma_f32 v73, v75, v92, v74
    v_cvt_pk_bf16_f32 v144, v72, v73
    v_lshlrev_b32 v72, 16, v22
    v_and_b32 v73, 0xffff0000, v22
    v_sub_f32 v72, v72, v77
    v_sub_f32 v73, v73, v77
    v_cvt_pk_bf16_f32 v74, v72, v73
    v_lshlrev_b32 v72, 16, v74
    v_and_b32 v73, 0xffff0000, v74
    v_mul_f32 v74, v72, v93
    v_fma_f32 v75, -v74, v85, v72
    v_fma_f32 v72, v75, v93, v74
    v_mul_f32 v74, v73, v93
    v_fma_f32 v75, -v74, v85, v73
    v_fma_f32 v73, v75, v93, v74
    v_cvt_pk_bf16_f32 v145, v72, v73
    v_lshlrev_b32 v12, 16, v161
    v_and_b32 v13, 0xffff0000, v161
    s_waitcnt vmcnt(0)
    v_lshlrev_b32 v72, 16, v144
    v_lshlrev_b32 v73, 16, v17
    v_lshlrev_b32 v74, 16, v170
    v_mul_f32 v72, v72, v12
    v_cvt_pk_bf16_f32 v72, v72, v72
    v_lshlrev_b32 v72, 16, v72
    v_add_f32 v72, v72, v74
    v_cvt_pk_bf16_f32 v72, v72, v72
    v_lshlrev_b32 v72, 16, v72
    v_add_f32 v14, v73, v72
    v_and_b32 v72, 0xffff0000, v144
    v_and_b32 v73, 0xffff0000, v17
    v_lshlrev_b32 v74, 16, v172
    v_mul_f32 v72, v72, v13
    v_cvt_pk_bf16_f32 v72, v72, v72
    v_lshlrev_b32 v72, 16, v72
    v_add_f32 v72, v72, v74
    v_cvt_pk_bf16_f32 v72, v72, v72
    v_lshlrev_b32 v72, 16, v72
    v_add_f32 v15, v73, v72
    v_cvt_pk_bf16_f32 v105, v14, v15
    v_lshlrev_b32 v72, 16, v145
    v_lshlrev_b32 v73, 16, v22
    v_and_b32 v74, 0xffff0000, v170
    v_mul_f32 v72, v72, v12
    v_cvt_pk_bf16_f32 v72, v72, v72
    v_lshlrev_b32 v72, 16, v72
    v_add_f32 v72, v72, v74
    v_cvt_pk_bf16_f32 v72, v72, v72
    v_lshlrev_b32 v72, 16, v72
    v_add_f32 v14, v73, v72
    v_and_b32 v72, 0xffff0000, v145
    v_and_b32 v73, 0xffff0000, v22
    v_and_b32 v74, 0xffff0000, v172
    v_mul_f32 v72, v72, v13
    v_cvt_pk_bf16_f32 v72, v72, v72
    v_lshlrev_b32 v72, 16, v72
    v_add_f32 v72, v72, v74
    v_cvt_pk_bf16_f32 v72, v72, v72
    v_lshlrev_b32 v72, 16, v72
    v_add_f32 v15, v73, v72
    v_cvt_pk_bf16_f32 v110, v14, v15
    v_lshlrev_b32 v72, 16, v18
    v_and_b32 v73, 0xffff0000, v18
    v_sub_f32 v72, v72, v76
    v_sub_f32 v73, v73, v76
    v_cvt_pk_bf16_f32 v74, v72, v73
    v_lshlrev_b32 v72, 16, v74
    v_and_b32 v73, 0xffff0000, v74
    v_mul_f32 v74, v72, v92
    v_fma_f32 v75, -v74, v84, v72
    v_fma_f32 v72, v75, v92, v74
    v_mul_f32 v74, v73, v92
    v_fma_f32 v75, -v74, v84, v73
    v_fma_f32 v73, v75, v92, v74
    v_cvt_pk_bf16_f32 v144, v72, v73
    v_lshlrev_b32 v72, 16, v23
    v_and_b32 v73, 0xffff0000, v23
    v_sub_f32 v72, v72, v77
    v_sub_f32 v73, v73, v77
    v_cvt_pk_bf16_f32 v74, v72, v73
    v_lshlrev_b32 v72, 16, v74
    v_and_b32 v73, 0xffff0000, v74
    v_mul_f32 v74, v72, v93
    v_fma_f32 v75, -v74, v85, v72
    v_fma_f32 v72, v75, v93, v74
    v_mul_f32 v74, v73, v93
    v_fma_f32 v75, -v74, v85, v73
    v_fma_f32 v73, v75, v93, v74
    v_cvt_pk_bf16_f32 v145, v72, v73
    v_lshlrev_b32 v12, 16, v162
    v_and_b32 v13, 0xffff0000, v162
    s_waitcnt vmcnt(0)
    v_lshlrev_b32 v72, 16, v144
    v_lshlrev_b32 v73, 16, v18
    v_lshlrev_b32 v74, 16, v174
    v_mul_f32 v72, v72, v12
    v_cvt_pk_bf16_f32 v72, v72, v72
    v_lshlrev_b32 v72, 16, v72
    v_add_f32 v72, v72, v74
    v_cvt_pk_bf16_f32 v72, v72, v72
    v_lshlrev_b32 v72, 16, v72
    v_add_f32 v14, v73, v72
    v_and_b32 v72, 0xffff0000, v144
    v_and_b32 v73, 0xffff0000, v18
    v_lshlrev_b32 v74, 16, v176
    v_mul_f32 v72, v72, v13
    v_cvt_pk_bf16_f32 v72, v72, v72
    v_lshlrev_b32 v72, 16, v72
    v_add_f32 v72, v72, v74
    v_cvt_pk_bf16_f32 v72, v72, v72
    v_lshlrev_b32 v72, 16, v72
    v_add_f32 v15, v73, v72
    v_cvt_pk_bf16_f32 v106, v14, v15
    v_lshlrev_b32 v72, 16, v145
    v_lshlrev_b32 v73, 16, v23
    v_and_b32 v74, 0xffff0000, v174
    v_mul_f32 v72, v72, v12
    v_cvt_pk_bf16_f32 v72, v72, v72
    v_lshlrev_b32 v72, 16, v72
    v_add_f32 v72, v72, v74
    v_cvt_pk_bf16_f32 v72, v72, v72
    v_lshlrev_b32 v72, 16, v72
    v_add_f32 v14, v73, v72
    v_and_b32 v72, 0xffff0000, v145
    v_and_b32 v73, 0xffff0000, v23
    v_and_b32 v74, 0xffff0000, v176
    v_mul_f32 v72, v72, v13
    v_cvt_pk_bf16_f32 v72, v72, v72
    v_lshlrev_b32 v72, 16, v72
    v_add_f32 v72, v72, v74
    v_cvt_pk_bf16_f32 v72, v72, v72
    v_lshlrev_b32 v72, 16, v72
    v_add_f32 v15, v73, v72
    v_cvt_pk_bf16_f32 v111, v14, v15
    v_lshlrev_b32 v72, 16, v19
    v_and_b32 v73, 0xffff0000, v19
    v_sub_f32 v72, v72, v76
    v_sub_f32 v73, v73, v76
    v_cvt_pk_bf16_f32 v74, v72, v73
    v_lshlrev_b32 v72, 16, v74
    v_and_b32 v73, 0xffff0000, v74
    v_mul_f32 v74, v72, v92
    v_fma_f32 v75, -v74, v84, v72
    v_fma_f32 v72, v75, v92, v74
    v_mul_f32 v74, v73, v92
    v_fma_f32 v75, -v74, v84, v73
    v_fma_f32 v73, v75, v92, v74
    v_cvt_pk_bf16_f32 v144, v72, v73
    v_lshlrev_b32 v72, 16, v24
    v_and_b32 v73, 0xffff0000, v24
    v_sub_f32 v72, v72, v77
    v_sub_f32 v73, v73, v77
    v_cvt_pk_bf16_f32 v74, v72, v73
    v_lshlrev_b32 v72, 16, v74
    v_and_b32 v73, 0xffff0000, v74
    v_mul_f32 v74, v72, v93
    v_fma_f32 v75, -v74, v85, v72
    v_fma_f32 v72, v75, v93, v74
    v_mul_f32 v74, v73, v93
    v_fma_f32 v75, -v74, v85, v73
    v_fma_f32 v73, v75, v93, v74
    v_cvt_pk_bf16_f32 v145, v72, v73
    v_lshlrev_b32 v12, 16, v163
    v_and_b32 v13, 0xffff0000, v163
    s_waitcnt vmcnt(0)
    v_lshlrev_b32 v72, 16, v144
    v_lshlrev_b32 v73, 16, v19
    v_lshlrev_b32 v74, 16, v178
    v_mul_f32 v72, v72, v12
    v_cvt_pk_bf16_f32 v72, v72, v72
    v_lshlrev_b32 v72, 16, v72
    v_add_f32 v72, v72, v74
    v_cvt_pk_bf16_f32 v72, v72, v72
    v_lshlrev_b32 v72, 16, v72
    v_add_f32 v14, v73, v72
    v_and_b32 v72, 0xffff0000, v144
    v_and_b32 v73, 0xffff0000, v19
    v_lshlrev_b32 v74, 16, v180
    v_mul_f32 v72, v72, v13
    v_cvt_pk_bf16_f32 v72, v72, v72
    v_lshlrev_b32 v72, 16, v72
    v_add_f32 v72, v72, v74
    v_cvt_pk_bf16_f32 v72, v72, v72
    v_lshlrev_b32 v72, 16, v72
    v_add_f32 v15, v73, v72
    v_cvt_pk_bf16_f32 v107, v14, v15
    v_lshlrev_b32 v72, 16, v145
    v_lshlrev_b32 v73, 16, v24
    v_and_b32 v74, 0xffff0000, v178
    v_mul_f32 v72, v72, v12
    v_cvt_pk_bf16_f32 v72, v72, v72
    v_lshlrev_b32 v72, 16, v72
    v_add_f32 v72, v72, v74
    v_cvt_pk_bf16_f32 v72, v72, v72
    v_lshlrev_b32 v72, 16, v72
    v_add_f32 v14, v73, v72
    v_and_b32 v72, 0xffff0000, v145
    v_and_b32 v73, 0xffff0000, v24
    v_and_b32 v74, 0xffff0000, v180
    v_mul_f32 v72, v72, v13
    v_cvt_pk_bf16_f32 v72, v72, v72
    v_lshlrev_b32 v72, 16, v72
    v_add_f32 v72, v72, v74
    v_cvt_pk_bf16_f32 v72, v72, v72
    v_lshlrev_b32 v72, 16, v72
    v_add_f32 v15, v73, v72
    v_cvt_pk_bf16_f32 v112, v14, v15
    v_lshlrev_b32 v72, 16, v20
    v_and_b32 v73, 0xffff0000, v20
    v_sub_f32 v72, v72, v76
    v_sub_f32 v73, v73, v76
    v_cvt_pk_bf16_f32 v74, v72, v73
    v_lshlrev_b32 v72, 16, v74
    v_and_b32 v73, 0xffff0000, v74
    v_mul_f32 v74, v72, v92
    v_fma_f32 v75, -v74, v84, v72
    v_fma_f32 v72, v75, v92, v74
    v_mul_f32 v74, v73, v92
    v_fma_f32 v75, -v74, v84, v73
    v_fma_f32 v73, v75, v92, v74
    v_cvt_pk_bf16_f32 v144, v72, v73
    v_lshlrev_b32 v72, 16, v25
    v_and_b32 v73, 0xffff0000, v25
    v_sub_f32 v72, v72, v77
    v_sub_f32 v73, v73, v77
    v_cvt_pk_bf16_f32 v74, v72, v73
    v_lshlrev_b32 v72, 16, v74
    v_and_b32 v73, 0xffff0000, v74
    v_mul_f32 v74, v72, v93
    v_fma_f32 v75, -v74, v85, v72
    v_fma_f32 v72, v75, v93, v74
    v_mul_f32 v74, v73, v93
    v_fma_f32 v75, -v74, v85, v73
    v_fma_f32 v73, v75, v93, v74
    v_cvt_pk_bf16_f32 v145, v72, v73
    v_lshlrev_b32 v12, 16, v164
    v_and_b32 v13, 0xffff0000, v164
    s_waitcnt vmcnt(0)
    v_lshlrev_b32 v72, 16, v144
    v_lshlrev_b32 v73, 16, v20
    v_lshlrev_b32 v74, 16, v182
    v_mul_f32 v72, v72, v12
    v_cvt_pk_bf16_f32 v72, v72, v72
    v_lshlrev_b32 v72, 16, v72
    v_add_f32 v72, v72, v74
    v_cvt_pk_bf16_f32 v72, v72, v72
    v_lshlrev_b32 v72, 16, v72
    v_add_f32 v14, v73, v72
    v_and_b32 v72, 0xffff0000, v144
    v_and_b32 v73, 0xffff0000, v20
    v_lshlrev_b32 v74, 16, v184
    v_mul_f32 v72, v72, v13
    v_cvt_pk_bf16_f32 v72, v72, v72
    v_lshlrev_b32 v72, 16, v72
    v_add_f32 v72, v72, v74
    v_cvt_pk_bf16_f32 v72, v72, v72
    v_lshlrev_b32 v72, 16, v72
    v_add_f32 v15, v73, v72
    v_cvt_pk_bf16_f32 v108, v14, v15
    v_lshlrev_b32 v72, 16, v145
    v_lshlrev_b32 v73, 16, v25
    v_and_b32 v74, 0xffff0000, v182
    v_mul_f32 v72, v72, v12
    v_cvt_pk_bf16_f32 v72, v72, v72
    v_lshlrev_b32 v72, 16, v72
    v_add_f32 v72, v72, v74
    v_cvt_pk_bf16_f32 v72, v72, v72
    v_lshlrev_b32 v72, 16, v72
    v_add_f32 v14, v73, v72
    v_and_b32 v72, 0xffff0000, v145
    v_and_b32 v73, 0xffff0000, v25
    v_and_b32 v74, 0xffff0000, v184
    v_mul_f32 v72, v72, v13
    v_cvt_pk_bf16_f32 v72, v72, v72
    v_lshlrev_b32 v72, 16, v72
    v_add_f32 v72, v72, v74
    v_cvt_pk_bf16_f32 v72, v72, v72
    v_lshlrev_b32 v72, 16, v72
    v_add_f32 v15, v73, v72
    v_cvt_pk_bf16_f32 v113, v14, v15
    v_mov_b32 v56, 0
    v_lshlrev_b32 v72, 16, v104
    v_and_b32 v73, 0xffff0000, v104
    v_add_f32 v56, v56, v72
    v_add_f32 v56, v56, v73
    v_lshlrev_b32 v72, 16, v105
    v_and_b32 v73, 0xffff0000, v105
    v_add_f32 v56, v56, v72
    v_add_f32 v56, v56, v73
    v_lshlrev_b32 v72, 16, v106
    v_and_b32 v73, 0xffff0000, v106
    v_add_f32 v56, v56, v72
    v_add_f32 v56, v56, v73
    v_lshlrev_b32 v72, 16, v107
    v_and_b32 v73, 0xffff0000, v107
    v_add_f32 v56, v56, v72
    v_add_f32 v56, v56, v73
    v_lshlrev_b32 v72, 16, v108
    v_and_b32 v73, 0xffff0000, v108
    v_add_f32 v56, v56, v72
    v_add_f32 v56, v56, v73
    v_mov_b32 v57, 0
    v_lshlrev_b32 v72, 16, v109
    v_and_b32 v73, 0xffff0000, v109
    v_add_f32 v57, v57, v72
    v_add_f32 v57, v57, v73
    v_lshlrev_b32 v72, 16, v110
    v_and_b32 v73, 0xffff0000, v110
    v_add_f32 v57, v57, v72
    v_add_f32 v57, v57, v73
    v_lshlrev_b32 v72, 16, v111
    v_and_b32 v73, 0xffff0000, v111
    v_add_f32 v57, v57, v72
    v_add_f32 v57, v57, v73
    v_lshlrev_b32 v72, 16, v112
    v_and_b32 v73, 0xffff0000, v112
    v_add_f32 v57, v57, v72
    v_add_f32 v57, v57, v73
    v_lshlrev_b32 v72, 16, v113
    v_and_b32 v73, 0xffff0000, v113
    v_add_f32 v57, v57, v72
    v_add_f32 v57, v57, v73
    s_nop 1
    v_add_f32_dpp v56, v56, v56 row_shr:1 row_mask:0xf bank_mask:0xf bound_ctrl:0
    v_add_f32_dpp v57, v57, v57 row_shr:1 row_mask:0xf bank_mask:0xf bound_ctrl:0
    s_nop 1
    v_add_f32_dpp v56, v56, v56 row_shr:2 row_mask:0xf bank_mask:0xf bound_ctrl:0
    v_add_f32_dpp v57, v57, v57 row_shr:2 row_mask:0xf bank_mask:0xf bound_ctrl:0
    s_nop 1
    v_add_f32_dpp v56, v56, v56 row_shr:4 row_mask:0xf bank_mask:0xf bound_ctrl:0
    v_add_f32_dpp v57, v57, v57 row_shr:4 row_mask:0xf bank_mask:0xf bound_ctrl:0
    s_nop 1
    v_add_f32_dpp v56, v56, v56 row_shr:8 row_mask:0xf bank_mask:0xf bound_ctrl:0
    v_add_f32_dpp v57, v57, v57 row_shr:8 row_mask:0xf bank_mask:0xf bound_ctrl:0
    s_nop 1
    v_add_f32_dpp v56, v56, v56 row_bcast:15 row_mask:0xa bank_mask:0xf
    v_add_f32_dpp v57, v57, v57 row_bcast:15 row_mask:0xa bank_mask:0xf
    s_nop 1
    v_add_f32_dpp v56, v56, v56 row_bcast:31 row_mask:0xc bank_mask:0xf
    v_add_f32_dpp v57, v57, v57 row_bcast:31 row_mask:0xc bank_mask:0xf
    s_nop 1
    v_readlane_b32 s70, v56, 63
    v_readlane_b32 s71, v57, 63
    s_nop 1
    v_mov_b32 v56, s70
    v_mov_b32 v57, s71
    v_mul_f32 v76, 0x3acccccd, v56
    v_mov_b32 v56, 0
    v_lshlrev_b32 v72, 16, v104
    v_and_b32 v73, 0xffff0000, v104
    v_sub_f32 v72, v72, v76
    v_sub_f32 v73, v73, v76
    v_fmac_f32 v56, v72, v72
    v_fmac_f32 v56, v73, v73
    v_lshlrev_b32 v72, 16, v105
    v_and_b32 v73, 0xffff0000, v105
    v_sub_f32 v72, v72, v76
    v_sub_f32 v73, v73, v76
    v_fmac_f32 v56, v72, v72
    v_fmac_f32 v56, v73, v73
    v_lshlrev_b32 v72, 16, v106
    v_and_b32 v73, 0xffff0000, v106
    v_sub_f32 v72, v72, v76
    v_sub_f32 v73, v73, v76
    v_fmac_f32 v56, v72, v72
    v_fmac_f32 v56, v73, v73
    v_lshlrev_b32 v72, 16, v107
    v_and_b32 v73, 0xffff0000, v107
    v_sub_f32 v72, v72, v76
    v_sub_f32 v73, v73, v76
    v_fmac_f32 v56, v72, v72
    v_fmac_f32 v56, v73, v73
    v_lshlrev_b32 v72, 16, v108
    v_and_b32 v73, 0xffff0000, v108
    v_sub_f32 v72, v72, v76
    v_sub_f32 v73, v73, v76
    v_fmac_f32 v56, v72, v72
    v_fmac_f32 v56, v73, v73
    v_mul_f32 v77, 0x3acccccd, v57
    v_mov_b32 v57, 0
    v_lshlrev_b32 v72, 16, v109
    v_and_b32 v73, 0xffff0000, v109
    v_sub_f32 v72, v72, v77
    v_sub_f32 v73, v73, v77
    v_fmac_f32 v57, v72, v72
    v_fmac_f32 v57, v73, v73
    v_lshlrev_b32 v72, 16, v110
    v_and_b32 v73, 0xffff0000, v110
    v_sub_f32 v72, v72, v77
    v_sub_f32 v73, v73, v77
    v_fmac_f32 v57, v72, v72
    v_fmac_f32 v57, v73, v73
    v_lshlrev_b32 v72, 16, v111
    v_and_b32 v73, 0xffff0000, v111
    v_sub_f32 v72, v72, v77
    v_sub_f32 v73, v73, v77
    v_fmac_f32 v57, v72, v72
    v_fmac_f32 v57, v73, v73
    v_lshlrev_b32 v72, 16, v112
    v_and_b32 v73, 0xffff0000, v112
    v_sub_f32 v72, v72, v77
    v_sub_f32 v73, v73, v77
    v_fmac_f32 v57, v72, v72
    v_fmac_f32 v57, v73, v73
    v_lshlrev_b32 v72, 16, v113
    v_and_b32 v73, 0xffff0000, v113
    v_sub_f32 v72, v72, v77
    v_sub_f32 v73, v73, v77
    v_fmac_f32 v57, v72, v72
    v_fmac_f32 v57, v73, v73
    s_nop 1
    v_add_f32_dpp v56, v56, v56 row_shr:1 row_mask:0xf bank_mask:0xf bound_ctrl:0
    v_add_f32_dpp v57, v57, v57 row_shr:1 row_mask:0xf bank_mask:0xf bound_ctrl:0
    s_nop 1
    v_add_f32_dpp v56, v56, v56 row_shr:2 row_mask:0xf bank_mask:0xf bound_ctrl:0
    v_add_f32_dpp v57, v57, v57 row_shr:2 row_mask:0xf bank_mask:0xf bound_ctrl:0
    s_nop 1
    v_add_f32_dpp v56, v56, v56 row_shr:4 row_mask:0xf bank_mask:0xf bound_ctrl:0
    v_add_f32_dpp v57, v57, v57 row_shr:4 row_mask:0xf bank_mask:0xf bound_ctrl:0
    s_nop 1
    v_add_f32_dpp v56, v56, v56 row_shr:8 row_mask:0xf bank_mask:0xf bound_ctrl:0
    v_add_f32_dpp v57, v57, v57 row_shr:8 row_mask:0xf bank_mask:0xf bound_ctrl:0
    s_nop 1
    v_add_f32_dpp v56, v56, v56 row_bcast:15 row_mask:0xa bank_mask:0xf
    v_add_f32_dpp v57, v57, v57 row_bcast:15 row_mask:0xa bank_mask:0xf
    s_nop 1
    v_add_f32_dpp v56, v56, v56 row_bcast:31 row_mask:0xc bank_mask:0xf
    v_add_f32_dpp v57, v57, v57 row_bcast:31 row_mask:0xc bank_mask:0xf
    s_nop 1
    v_readlane_b32 s70, v56, 63
    v_readlane_b32 s71, v57, 63
    s_nop 1
    v_mov_b32 v56, s70
    v_mov_b32 v57, s71
    v_mul_f32 v72, 0x3acccccd, v56
    v_cvt_pk_bf16_f32 v72, v72, v72
    v_lshlrev_b32 v72, 16, v72
    v_add_f32 v72, 0x3727c5ac, v72
    v_cvt_pk_bf16_f32 v72, v72, v72
    v_lshlrev_b32 v72, 16, v72
    v_sqrt_f32 v72, v72
    s_nop 0
    v_cvt_pk_bf16_f32 v84, v72, v72
    v_lshlrev_b32 v84, 16, v84
    v_rcp_f32 v92, v84
    v_cvt_pk_bf16_f32 v76, v76, v76
    v_lshlrev_b32 v76, 16, v76
    v_mul_f32 v72, 0x3acccccd, v57
    v_cvt_pk_bf16_f32 v72, v72, v72
    v_lshlrev_b32 v72, 16, v72
    v_add_f32 v72, 0x3727c5ac, v72
    v_cvt_pk_bf16_f32 v72, v72, v72
    v_lshlrev_b32 v72, 16, v72
    v_sqrt_f32 v72, v72
    s_nop 0
    v_cvt_pk_bf16_f32 v85, v72, v72
    v_lshlrev_b32 v85, 16, v85
    v_rcp_f32 v93, v85
    v_cvt_pk_bf16_f32 v77, v77, v77
    v_lshlrev_b32 v77, 16, v77
    s_add_u32 s17, s16, 12582912
    s_add_u32 s18, s16, 16777216
    v_lshlrev_b32 v72, 16, v104
    v_and_b32 v73, 0xffff0000, v104
    v_sub_f32 v72, v72, v76
    v_sub_f32 v73, v73, v76
    v_cvt_pk_bf16_f32 v74, v72, v73
    v_lshlrev_b32 v72, 16, v74
    v_and_b32 v73, 0xffff0000, v74
    v_mul_f32 v74, v72, v92
    v_fma_f32 v75, -v74, v84, v72
    v_fma_f32 v72, v75, v92, v74
    v_mul_f32 v74, v73, v92
    v_fma_f32 v75, -v74, v84, v73
    v_fma_f32 v73, v75, v92, v74
    v_cvt_pk_bf16_f32 v12, v72, v73
    buffer_store_dword v104, v3, s[12:15], s17 offen offset:0
    buffer_store_dword v12, v3, s[12:15], s18 offen offset:0
    v_lshlrev_b32 v72, 16, v105
    v_and_b32 v73, 0xffff0000, v105
    v_sub_f32 v72, v72, v76
    v_sub_f32 v73, v73, v76
    v_cvt_pk_bf16_f32 v74, v72, v73
    v_lshlrev_b32 v72, 16, v74
    v_and_b32 v73, 0xffff0000, v74
    v_mul_f32 v74, v72, v92
    v_fma_f32 v75, -v74, v84, v72
    v_fma_f32 v72, v75, v92, v74
    v_mul_f32 v74, v73, v92
    v_fma_f32 v75, -v74, v84, v73
    v_fma_f32 v73, v75, v92, v74
    v_cvt_pk_bf16_f32 v12, v72, v73
    buffer_store_dword v105, v3, s[12:15], s17 offen offset:256
    buffer_store_dword v12, v3, s[12:15], s18 offen offset:256
    v_lshlrev_b32 v72, 16, v106
    v_and_b32 v73, 0xffff0000, v106
    v_sub_f32 v72, v72, v76
    v_sub_f32 v73, v73, v76
    v_cvt_pk_bf16_f32 v74, v72, v73
    v_lshlrev_b32 v72, 16, v74
    v_and_b32 v73, 0xffff0000, v74
    v_mul_f32 v74, v72, v92
    v_fma_f32 v75, -v74, v84, v72
    v_fma_f32 v72, v75, v92, v74
    v_mul_f32 v74, v73, v92
    v_fma_f32 v75, -v74, v84, v73
    v_fma_f32 v73, v75, v92, v74
    v_cvt_pk_bf16_f32 v12, v72, v73
    buffer_store_dword v106, v3, s[12:15], s17 offen offset:512
    buffer_store_dword v12, v3, s[12:15], s18 offen offset:512
    v_lshlrev_b32 v72, 16, v107
    v_and_b32 v73, 0xffff0000, v107
    v_sub_f32 v72, v72, v76
    v_sub_f32 v73, v73, v76
    v_cvt_pk_bf16_f32 v74, v72, v73
    v_lshlrev_b32 v72, 16, v74
    v_and_b32 v73, 0xffff0000, v74
    v_mul_f32 v74, v72, v92
    v_fma_f32 v75, -v74, v84, v72
    v_fma_f32 v72, v75, v92, v74
    v_mul_f32 v74, v73, v92
    v_fma_f32 v75, -v74, v84, v73
    v_fma_f32 v73, v75, v92, v74
    v_cvt_pk_bf16_f32 v12, v72, v73
    buffer_store_dword v107, v3, s[12:15], s17 offen offset:768
    buffer_store_dword v12, v3, s[12:15], s18 offen offset:768
    v_lshlrev_b32 v72, 16, v108
    v_and_b32 v73, 0xffff0000, v108
    v_sub_f32 v72, v72, v76
    v_sub_f32 v73, v73, v76
    v_cvt_pk_bf16_f32 v74, v72, v73
    v_lshlrev_b32 v72, 16, v74
    v_and_b32 v73, 0xffff0000, v74
    v_mul_f32 v74, v72, v92
    v_fma_f32 v75, -v74, v84, v72
    v_fma_f32 v72, v75, v92, v74
    v_mul_f32 v74, v73, v92
    v_fma_f32 v75, -v74, v84, v73
    v_fma_f32 v73, v75, v92, v74
    v_cvt_pk_bf16_f32 v12, v72, v73
    buffer_store_dword v108, v3, s[12:15], s17 offen offset:1024
    buffer_store_dword v12, v3, s[12:15], s18 offen offset:1024
    s_add_u32 s17, s16, 12584192
    s_add_u32 s18, s16, 16778496
    v_lshlrev_b32 v72, 16, v109
    v_and_b32 v73, 0xffff0000, v109
    v_sub_f32 v72, v72, v77
    v_sub_f32 v73, v73, v77
    v_cvt_pk_bf16_f32 v74, v72, v73
    v_lshlrev_b32 v72, 16, v74
    v_and_b32 v73, 0xffff0000, v74
    v_mul_f32 v74, v72, v93
    v_fma_f32 v75, -v74, v85, v72
    v_fma_f32 v72, v75, v93, v74
    v_mul_f32 v74, v73, v93
    v_fma_f32 v75, -v74, v85, v73
    v_fma_f32 v73, v75, v93, v74
    v_cvt_pk_bf16_f32 v12, v72, v73
    buffer_store_dword v109, v3, s[12:15], s17 offen offset:0
    buffer_store_dword v12, v3, s[12:15], s18 offen offset:0
    v_lshlrev_b32 v72, 16, v110
    v_and_b32 v73, 0xffff0000, v110
    v_sub_f32 v72, v72, v77
    v_sub_f32 v73, v73, v77
    v_cvt_pk_bf16_f32 v74, v72, v73
    v_lshlrev_b32 v72, 16, v74
    v_and_b32 v73, 0xffff0000, v74
    v_mul_f32 v74, v72, v93
    v_fma_f32 v75, -v74, v85, v72
    v_fma_f32 v72, v75, v93, v74
    v_mul_f32 v74, v73, v93
    v_fma_f32 v75, -v74, v85, v73
    v_fma_f32 v73, v75, v93, v74
    v_cvt_pk_bf16_f32 v12, v72, v73
    buffer_store_dword v110, v3, s[12:15], s17 offen offset:256
    buffer_store_dword v12, v3, s[12:15], s18 offen offset:256
    v_lshlrev_b32 v72, 16, v111
    v_and_b32 v73, 0xffff0000, v111
    v_sub_f32 v72, v72, v77
    v_sub_f32 v73, v73, v77
    v_cvt_pk_bf16_f32 v74, v72, v73
    v_lshlrev_b32 v72, 16, v74
    v_and_b32 v73, 0xffff0000, v74
    v_mul_f32 v74, v72, v93
    v_fma_f32 v75, -v74, v85, v72
    v_fma_f32 v72, v75, v93, v74
    v_mul_f32 v74, v73, v93
    v_fma_f32 v75, -v74, v85, v73
    v_fma_f32 v73, v75, v93, v74
    v_cvt_pk_bf16_f32 v12, v72, v73
    buffer_store_dword v111, v3, s[12:15], s17 offen offset:512
    buffer_store_dword v12, v3, s[12:15], s18 offen offset:512
    v_lshlrev_b32 v72, 16, v112
    v_and_b32 v73, 0xffff0000, v112
    v_sub_f32 v72, v72, v77
    v_sub_f32 v73, v73, v77
    v_cvt_pk_bf16_f32 v74, v72, v73
    v_lshlrev_b32 v72, 16, v74
    v_and_b32 v73, 0xffff0000, v74
    v_mul_f32 v74, v72, v93
    v_fma_f32 v75, -v74, v85, v72
    v_fma_f32 v72, v75, v93, v74
    v_mul_f32 v74, v73, v93
    v_fma_f32 v75, -v74, v85, v73
    v_fma_f32 v73, v75, v93, v74
    v_cvt_pk_bf16_f32 v12, v72, v73
    buffer_store_dword v112, v3, s[12:15], s17 offen offset:768
    buffer_store_dword v12, v3, s[12:15], s18 offen offset:768
    v_lshlrev_b32 v72, 16, v113
    v_and_b32 v73, 0xffff0000, v113
    v_sub_f32 v72, v72, v77
    v_sub_f32 v73, v73, v77
    v_cvt_pk_bf16_f32 v74, v72, v73
    v_lshlrev_b32 v72, 16, v74
    v_and_b32 v73, 0xffff0000, v74
    v_mul_f32 v74, v72, v93
    v_fma_f32 v75, -v74, v85, v72
    v_fma_f32 v72, v75, v93, v74
    v_mul_f32 v74, v73, v93
    v_fma_f32 v75, -v74, v85, v73
    v_fma_f32 v73, v75, v93, v74
    v_cvt_pk_bf16_f32 v12, v72, v73
    buffer_store_dword v113, v3, s[12:15], s17 offen offset:1024
    buffer_store_dword v12, v3, s[12:15], s18 offen offset:1024
ln2_end:
    s_endpgm
.globl gemm1_kernel
.p2align 8
.type gemm1_kernel,@function
gemm1_kernel:
    s_cmp_ge_u32 s2, 216
    s_cbranch_scc1 gemm1_kernel_end
    s_load_dwordx2 s[22:23], s[0:1], 88
    s_load_dwordx2 s[24:25], s[0:1], 104
    s_waitcnt lgkmcnt(0)
    s_mov_b32 s8, s24
    s_mov_b32 s9, s25
    s_mov_b32 s10, 67108864
    s_mov_b32 s11, 0x00020000
    s_mov_b32 s28, s22
    s_mov_b32 s29, s23
    s_mov_b32 s30, 2621440
    s_mov_b32 s31, 0x00020000
    s_and_b32 s33, s2, 7
    s_mul_i32 s33, s33, 27
    s_lshr_b32 s2, s2, 3
    s_add_u32 s2, s2, s33
    s_lshr_b32 s35, s2, 3
    s_and_b32 s34, s2, 7
    v_and_b32 v1, 63, v0
    v_lshrrev_b32 v2, 6, v0
    v_and_b32 v3, 31, v0
    v_lshrrev_b32 v4, 5, v1
    v_lshrrev_b32 v5, 1, v2
    v_and_b32 v6, 1, v2
    v_mov_b32 v11, v6
    s_nop 0
    v_readfirstlane_b32 s41, v2
    s_mul_i32 s36, s34, 327680
    s_add_u32 s36, s36, 16777216
    v_lshrrev_b32 v7, 4, v1
    v_lshl_add_u32 v7, v11, 2, v7
    v_and_b32 v8, 7, v1
    v_xor_b32 v7, v7, v8
    v_lshrrev_b32 v8, 3, v1
    v_mul_u32_u24 v10, 1280, v8
    v_lshl_add_u32 v10, v7, 4, v10
    s_mul_i32 s37, s35, 81920
    s_add_u32 s38, s37, 33554432
    s_add_u32 s37, s37, 29360128
    s_mul_i32 s42, s41, 10240
    s_add_u32 s36, s36, s42
    s_add_u32 s37, s37, s42
    s_add_u32 s38, s38, s42
    s_lshl_b32 s43, s41, 10
    v_lshrrev_b32 v7, 1, v3
    v_and_b32 v7, 7, v7
    v_lshlrev_b32 v8, 7, v3
    v_add_u32 v9, 0, v4
    v_xor_b32 v9, v9, v7
    v_lshl_add_u32 v9, v9, 4, v8
    v_mul_u32_u24 v12, 8192, v5
    v_add_u32 v12, v12, v9
    v_mul_u32_u24 v16, 4096, v6
    v_add_u32 v16, v16, v9
    v_add_u32 v16, 32768, v16
    v_add_u32 v9, 2, v4
    v_xor_b32 v9, v9, v7
    v_lshl_add_u32 v9, v9, 4, v8
    v_mul_u32_u24 v13, 8192, v5
    v_add_u32 v13, v13, v9
    v_mul_u32_u24 v17, 4096, v6
    v_add_u32 v17, v17, v9
    v_add_u32 v17, 32768, v17
    v_add_u32 v9, 4, v4
    v_xor_b32 v9, v9, v7
    v_lshl_add_u32 v9, v9, 4, v8
    v_mul_u32_u24 v14, 8192, v5
    v_add_u32 v14, v14, v9
    v_mul_u32_u24 v18, 4096, v6
    v_add_u32 v18, v18, v9
    v_add_u32 v18, 32768, v18
    v_add_u32 v9, 6, v4
    v_xor_b32 v9, v9, v7
    v_lshl_add_u32 v9, v9, 4, v8
    v_mul_u32_u24 v15, 8192, v5
    v_add_u32 v15, v15, v9
    v_mul_u32_u24 v19, 4096, v6
    v_add_u32 v19, v19, v9
    v_add_u32 v19, 32768, v19
    v_mov_b32 v56, 0
    v_mov_b32 v57, 0
    v_mov_b32 v58, 0
    v_mov_b32 v59, 0
    v_mov_b32 v60, 0
    v_mov_b32 v61, 0
    v_mov_b32 v62, 0
    v_mov_b32 v63, 0
    v_mov_b32 v64, 0
    v_mov_b32 v65, 0
    v_mov_b32 v66, 0
    v_mov_b32 v67, 0
    v_mov_b32 v68, 0
    v_mov_b32 v69, 0
    v_mov_b32 v70, 0
    v_mov_b32 v71, 0
    v_mov_b32 v72, 0
    v_mov_b32 v73, 0
    v_mov_b32 v74, 0
    v_mov_b32 v75, 0
    v_mov_b32 v76, 0
    v_mov_b32 v77, 0
    v_mov_b32 v78, 0
    v_mov_b32 v79, 0
    v_mov_b32 v80, 0
    v_mov_b32 v81, 0
    v_mov_b32 v82, 0
    v_mov_b32 v83, 0
    v_mov_b32 v84, 0
    v_mov_b32 v85, 0
    v_mov_b32 v86, 0
    v_mov_b32 v87, 0
    v_mov_b32 v88, 0
    v_mov_b32 v89, 0
    v_mov_b32 v90, 0
    v_mov_b32 v91, 0
    v_mov_b32 v92, 0
    v_mov_b32 v93, 0
    v_mov_b32 v94, 0
    v_mov_b32 v95, 0
    v_mov_b32 v96, 0
    v_mov_b32 v97, 0
    v_mov_b32 v98, 0
    v_mov_b32 v99, 0
    v_mov_b32 v100, 0
    v_mov_b32 v101, 0
    v_mov_b32 v102, 0
    v_mov_b32 v103, 0
    v_mov_b32 v104, 0
    v_mov_b32 v105, 0
    v_mov_b32 v106, 0
    v_mov_b32 v107, 0
    v_mov_b32 v108, 0
    v_mov_b32 v109, 0
    v_mov_b32 v110, 0
    v_mov_b32 v111, 0
    v_mov_b32 v112, 0
    v_mov_b32 v113, 0
    v_mov_b32 v114, 0
    v_mov_b32 v115, 0
    v_mov_b32 v116, 0
    v_mov_b32 v117, 0
    v_mov_b32 v118, 0
    v_mov_b32 v119, 0
    v_add_u32 v120, 49152, v12
    v_add_u32 v121, 49152, v13
    v_add_u32 v122, 49152, v14
    v_add_u32 v123, 49152, v15
    v_add_u32 v124, 49152, v16
    v_add_u32 v125, 49152, v17
    v_add_u32 v126, 49152, v18
    v_add_u32 v127, 49152, v19
    v_add_u32 v128, 98304, v12
    v_add_u32 v129, 98304, v13
    v_add_u32 v130, 98304, v14
    v_add_u32 v131, 98304, v15
    v_add_u32 v132, 98304, v16
    v_add_u32 v133, 98304, v17
    v_add_u32 v134, 98304, v18
    v_add_u32 v135, 98304, v19
    s_add_u32 s40, s36, 0
    s_add_u32 m0, s43, 0
    s_nop 0
    buffer_load_dwordx4 v10, s[8:11], s40 offen lds
    s_add_u32 s40, s36, 81920
    s_add_u32 m0, s43, 8192
    s_nop 0
    buffer_load_dwordx4 v10, s[8:11], s40 offen lds
    s_add_u32 s40, s36, 163840
    s_add_u32 m0, s43, 16384
    s_nop 0
    buffer_load_dwordx4 v10, s[8:11], s40 offen lds
    s_add_u32 s40, s36, 245760
    s_add_u32 m0, s43, 24576
    s_nop 0
    buffer_load_dwordx4 v10, s[8:11], s40 offen lds
    s_add_u32 s40, s37, 0
    s_add_u32 m0, s43, 32768
    s_nop 0
    buffer_load_dwordx4 v10, s[8:11], s40 offen lds
    s_add_u32 s40, s38, 0
    s_add_u32 m0, s43, 40960
    s_nop 0
    buffer_load_dwordx4 v10, s[8:11], s40 offen lds
    s_add_u32 s36, s36, 128
    s_add_u32 s37, s37, 128
    s_add_u32 s38, s38, 128
    s_add_u32 s40, s36, 0
    s_add_u32 m0, s43, 49152
    s_nop 0
    buffer_load_dwordx4 v10, s[8:11], s40 offen lds
    s_add_u32 s40, s36, 81920
    s_add_u32 m0, s43, 57344
    s_nop 0
    buffer_load_dwordx4 v10, s[8:11], s40 offen lds
    s_add_u32 s40, s36, 163840
    s_add_u32 m0, s43, 65536
    s_nop 0
    buffer_load_dwordx4 v10, s[8:11], s40 offen lds
    s_add_u32 s40, s36, 245760
    s_add_u32 m0, s43, 73728
    s_nop 0
    buffer_load_dwordx4 v10, s[8:11], s40 offen lds
    s_add_u32 s40, s37, 0
    s_add_u32 m0, s43, 81920
    s_nop 0
    buffer_load_dwordx4 v10, s[8:11], s40 offen lds
    s_add_u32 s40, s38, 0
    s_add_u32 m0, s43, 90112
    s_nop 0
    buffer_load_dwordx4 v10, s[8:11], s40 offen lds
    s_add_u32 s36, s36, 128
    s_add_u32 s37, s37, 128
    s_add_u32 s38, s38, 128
    s_waitcnt vmcnt(6)
    s_barrier
    ds_read_b128 v[144:147], v12 offset:0
    ds_read_b128 v[148:151], v12 offset:4096
    ds_read_b128 v[152:155], v16 offset:0
    ds_read_b128 v[156:159], v16 offset:8192
    ds_read_b128 v[160:163], v13 offset:0
    ds_read_b128 v[164:167], v13 offset:4096
    ds_read_b128 v[168:171], v17 offset:0
    ds_read_b128 v[172:175], v17 offset:8192
    ds_read_b128 v[176:179], v14 offset:0
    ds_read_b128 v[180:183], v14 offset:4096
    ds_read_b128 v[184:187], v18 offset:0
    ds_read_b128 v[188:191], v18 offset:8192
    ds_read_b128 v[192:195], v15 offset:0
    ds_read_b128 v[196:199], v15 offset:4096
    ds_read_b128 v[200:203], v19 offset:0
    ds_read_b128 v[204:207], v19 offset:8192
    s_waitcnt lgkmcnt(12)
    v_mfma_f32_32x32x16_bf16 v[56:71], v[152:155], v[144:147], v[56:71]
    v_mfma_f32_32x32x16_bf16 v[72:87], v[156:159], v[144:147], v[72:87]
    s_add_u32 s40, s36, 0
    s_add_u32 m0, s43, 98304
    s_nop 0
    buffer_load_dwordx4 v10, s[8:11], s40 offen lds
    v_mfma_f32_32x32x16_bf16 v[88:103], v[152:155], v[148:151], v[88:103]
    v_mfma_f32_32x32x16_bf16 v[104:119], v[156:159], v[148:151], v[104:119]
    s_add_u32 s40, s36, 81920
    s_add_u32 m0, s43, 106496
    s_nop 0
    buffer_load_dwordx4 v10, s[8:11], s40 offen lds
    s_waitcnt lgkmcnt(8)
    v_mfma_f32_32x32x16_bf16 v[56:71], v[168:171], v[160:163], v[56:71]
    v_mfma_f32_32x32x16_bf16 v[72:87], v[172:175], v[160:163], v[72:87]
    s_add_u32 s40, s36, 163840
    s_add_u32 m0, s43, 114688
    s_nop 0
    buffer_load_dwordx4 v10, s[8:11], s40 offen lds
    v_mfma_f32_32x32x16_bf16 v[88:103], v[168:171], v[164:167], v[88:103]
    v_mfma_f32_32x32x16_bf16 v[104:119], v[172:175], v[164:167], v[104:119]
    s_add_u32 s40, s36, 245760
    s_add_u32 m0, s43, 122880
    s_nop 0
    buffer_load_dwordx4 v10, s[8:11], s40 offen lds
    s_waitcnt lgkmcnt(4)
    v_mfma_f32_32x32x16_bf16 v[56:71], v[184:187], v[176:179], v[56:71]
    v_mfma_f32_32x32x16_bf16 v[72:87], v[188:191], v[176:179], v[72:87]
    s_add_u32 s40, s37, 0
    s_add_u32 m0, s43, 131072
    s_nop 0
    buffer_load_dwordx4 v10, s[8:11], s40 offen lds
    v_mfma_f32_32x32x16_bf16 v[88:103], v[184:187], v[180:183], v[88:103]
    v_mfma_f32_32x32x16_bf16 v[104:119], v[188:191], v[180:183], v[104:119]
    s_add_u32 s40, s38, 0
    s_add_u32 m0, s43, 139264
    s_nop 0
    buffer_load_dwordx4 v10, s[8:11], s40 offen lds
    s_add_u32 s36, s36, 128
    s_add_u32 s37, s37, 128
    s_add_u32 s38, s38, 128
    s_waitcnt lgkmcnt(0)
    v_mfma_f32_32x32x16_bf16 v[56:71], v[200:203], v[192:195], v[56:71]
    v_mfma_f32_32x32x16_bf16 v[72:87], v[204:207], v[192:195], v[72:87]
    v_mfma_f32_32x32x16_bf16 v[88:103], v[200:203], v[196:199], v[88:103]
    v_mfma_f32_32x32x16_bf16 v[104:119], v[204:207], v[196:199], v[104:119]
    s_waitcnt vmcnt(6)
    s_barrier
    ds_read_b128 v[144:147], v120 offset:0
    ds_read_b128 v[148:151], v120 offset:4096
    ds_read_b128 v[152:155], v124 offset:0
    ds_read_b128 v[156:159], v124 offset:8192
    ds_read_b128 v[160:163], v121 offset:0
    ds_read_b128 v[164:167], v121 offset:4096
    ds_read_b128 v[168:171], v125 offset:0
    ds_read_b128 v[172:175], v125 offset:8192
    ds_read_b128 v[176:179], v122 offset:0
    ds_read_b128 v[180:183], v122 offset:4096
    ds_read_b128 v[184:187], v126 offset:0
    ds_read_b128 v[188:191], v126 offset:8192
    ds_read_b128 v[192:195], v123 offset:0
    ds_read_b128 v[196:199], v123 offset:4096
    ds_read_b128 v[200:203], v127 offset:0
    ds_read_b128 v[204:207], v127 offset:8192
    s_waitcnt lgkmcnt(12)
    v_mfma_f32_32x32x16_bf16 v[56:71], v[152:155], v[144:147], v[56:71]
    v_mfma_f32_32x32x16_bf16 v[72:87], v[156:159], v[144:147], v[72:87]
    s_add_u32 s40, s36, 0
    s_add_u32 m0, s43, 0
    s_nop 0
    buffer_load_dwordx4 v10, s[8:11], s40 offen lds
    v_mfma_f32_32x32x16_bf16 v[88:103], v[152:155], v[148:151], v[88:103]
    v_mfma_f32_32x32x16_bf16 v[104:119], v[156:159], v[148:151], v[104:119]
    s_add_u32 s40, s36, 81920
    s_add_u32 m0, s43, 8192
    s_nop 0
    buffer_load_dwordx4 v10, s[8:11], s40 offen lds
    s_waitcnt lgkmcnt(8)
    v_mfma_f32_32x32x16_bf16 v[56:71], v[168:171], v[160:163], v[56:71]
    v_mfma_f32_32x32x16_bf16 v[72:87], v[172:175], v[160:163], v[72:87]
    s_add_u32 s40, s36, 163840
    s_add_u32 m0, s43, 16384
    s_nop 0
    buffer_load_dwordx4 v10, s[8:11], s40 offen lds
    v_mfma_f32_32x32x16_bf16 v[88:103], v[168:171], v[164:167], v[88:103]
    v_mfma_f32_32x32x16_bf16 v[104:119], v[172:175], v[164:167], v[104:119]
    s_add_u32 s40, s36, 245760
    s_add_u32 m0, s43, 24576
    s_nop 0
    buffer_load_dwordx4 v10, s[8:11], s40 offen lds
    s_waitcnt lgkmcnt(4)
    v_mfma_f32_32x32x16_bf16 v[56:71], v[184:187], v[176:179], v[56:71]
    v_mfma_f32_32x32x16_bf16 v[72:87], v[188:191], v[176:179], v[72:87]
    s_add_u32 s40, s37, 0
    s_add_u32 m0, s43, 32768
    s_nop 0
    buffer_load_dwordx4 v10, s[8:11], s40 offen lds
    v_mfma_f32_32x32x16_bf16 v[88:103], v[184:187], v[180:183], v[88:103]
    v_mfma_f32_32x32x16_bf16 v[104:119], v[188:191], v[180:183], v[104:119]
    s_add_u32 s40, s38, 0
    s_add_u32 m0, s43, 40960
    s_nop 0
    buffer_load_dwordx4 v10, s[8:11], s40 offen lds
    s_add_u32 s36, s36, 128
    s_add_u32 s37, s37, 128
    s_add_u32 s38, s38, 128
    s_waitcnt lgkmcnt(0)
    v_mfma_f32_32x32x16_bf16 v[56:71], v[200:203], v[192:195], v[56:71]
    v_mfma_f32_32x32x16_bf16 v[72:87], v[204:207], v[192:195], v[72:87]
    v_mfma_f32_32x32x16_bf16 v[88:103], v[200:203], v[196:199], v[88:103]
    v_mfma_f32_32x32x16_bf16 v[104:119], v[204:207], v[196:199], v[104:119]
    s_waitcnt vmcnt(6)
    s_barrier
    ds_read_b128 v[144:147], v128 offset:0
    ds_read_b128 v[148:151], v128 offset:4096
    ds_read_b128 v[152:155], v132 offset:0
    ds_read_b128 v[156:159], v132 offset:8192
    ds_read_b128 v[160:163], v129 offset:0
    ds_read_b128 v[164:167], v129 offset:4096
    ds_read_b128 v[168:171], v133 offset:0
    ds_read_b128 v[172:175], v133 offset:8192
    ds_read_b128 v[176:179], v130 offset:0
    ds_read_b128 v[180:183], v130 offset:4096
    ds_read_b128 v[184:187], v134 offset:0
    ds_read_b128 v[188:191], v134 offset:8192
    ds_read_b128 v[192:195], v131 offset:0
    ds_read_b128 v[196:199], v131 offset:4096
    ds_read_b128 v[200:203], v135 offset:0
    ds_read_b128 v[204:207], v135 offset:8192
    s_waitcnt lgkmcnt(12)
    v_mfma_f32_32x32x16_bf16 v[56:71], v[152:155], v[144:147], v[56:71]
    v_mfma_f32_32x32x16_bf16 v[72:87], v[156:159], v[144:147], v[72:87]
    s_add_u32 s40, s36, 0
    s_add_u32 m0, s43, 49152
    s_nop 0
    buffer_load_dwordx4 v10, s[8:11], s40 offen lds
    v_mfma_f32_32x32x16_bf16 v[88:103], v[152:155], v[148:151], v[88:103]
    v_mfma_f32_32x32x16_bf16 v[104:119], v[156:159], v[148:151], v[104:119]
    s_add_u32 s40, s36, 81920
    s_add_u32 m0, s43, 57344
    s_nop 0
    buffer_load_dwordx4 v10, s[8:11], s40 offen lds
    s_waitcnt lgkmcnt(8)
    v_mfma_f32_32x32x16_bf16 v[56:71], v[168:171], v[160:163], v[56:71]
    v_mfma_f32_32x32x16_bf16 v[72:87], v[172:175], v[160:163], v[72:87]
    s_add_u32 s40, s36, 163840
    s_add_u32 m0, s43, 65536
    s_nop 0
    buffer_load_dwordx4 v10, s[8:11], s40 offen lds
    v_mfma_f32_32x32x16_bf16 v[88:103], v[168:171], v[164:167], v[88:103]
    v_mfma_f32_32x32x16_bf16 v[104:119], v[172:175], v[164:167], v[104:119]
    s_add_u32 s40, s36, 245760
    s_add_u32 m0, s43, 73728
    s_nop 0
    buffer_load_dwordx4 v10, s[8:11], s40 offen lds
    s_waitcnt lgkmcnt(4)
    v_mfma_f32_32x32x16_bf16 v[56:71], v[184:187], v[176:179], v[56:71]
    v_mfma_f32_32x32x16_bf16 v[72:87], v[188:191], v[176:179], v[72:87]
    s_add_u32 s40, s37, 0
    s_add_u32 m0, s43, 81920
    s_nop 0
    buffer_load_dwordx4 v10, s[8:11], s40 offen lds
    v_mfma_f32_32x32x16_bf16 v[88:103], v[184:187], v[180:183], v[88:103]
    v_mfma_f32_32x32x16_bf16 v[104:119], v[188:191], v[180:183], v[104:119]
    s_add_u32 s40, s38, 0
    s_add_u32 m0, s43, 90112
    s_nop 0
    buffer_load_dwordx4 v10, s[8:11], s40 offen lds
    s_add_u32 s36, s36, 128
    s_add_u32 s37, s37, 128
    s_add_u32 s38, s38, 128
    s_waitcnt lgkmcnt(0)
    v_mfma_f32_32x32x16_bf16 v[56:71], v[200:203], v[192:195], v[56:71]
    v_mfma_f32_32x32x16_bf16 v[72:87], v[204:207], v[192:195], v[72:87]
    v_mfma_f32_32x32x16_bf16 v[88:103], v[200:203], v[196:199], v[88:103]
    v_mfma_f32_32x32x16_bf16 v[104:119], v[204:207], v[196:199], v[104:119]
    s_waitcnt vmcnt(6)
    s_barrier
    ds_read_b128 v[144:147], v12 offset:0
    ds_read_b128 v[148:151], v12 offset:4096
    ds_read_b128 v[152:155], v16 offset:0
    ds_read_b128 v[156:159], v16 offset:8192
    ds_read_b128 v[160:163], v13 offset:0
    ds_read_b128 v[164:167], v13 offset:4096
    ds_read_b128 v[168:171], v17 offset:0
    ds_read_b128 v[172:175], v17 offset:8192
    ds_read_b128 v[176:179], v14 offset:0
    ds_read_b128 v[180:183], v14 offset:4096
    ds_read_b128 v[184:187], v18 offset:0
    ds_read_b128 v[188:191], v18 offset:8192
    ds_read_b128 v[192:195], v15 offset:0
    ds_read_b128 v[196:199], v15 offset:4096
    ds_read_b128 v[200:203], v19 offset:0
    ds_read_b128 v[204:207], v19 offset:8192
    s_waitcnt lgkmcnt(12)
    v_mfma_f32_32x32x16_bf16 v[56:71], v[152:155], v[144:147], v[56:71]
    v_mfma_f32_32x32x16_bf16 v[72:87], v[156:159], v[144:147], v[72:87]
    s_add_u32 s40, s36, 0
    s_add_u32 m0, s43, 98304
    s_nop 0
    buffer_load_dwordx4 v10, s[8:11], s40 offen lds
    v_mfma_f32_32x32x16_bf16 v[88:103], v[152:155], v[148:151], v[88:103]
    v_mfma_f32_32x32x16_bf16 v[104:119], v[156:159], v[148:151], v[104:119]
    s_add_u32 s40, s36, 81920
    s_add_u32 m0, s43, 106496
    s_nop 0
    buffer_load_dwordx4 v10, s[8:11], s40 offen lds
    s_waitcnt lgkmcnt(8)
    v_mfma_f32_32x32x16_bf16 v[56:71], v[168:171], v[160:163], v[56:71]
    v_mfma_f32_32x32x16_bf16 v[72:87], v[172:175], v[160:163], v[72:87]
    s_add_u32 s40, s36, 163840
    s_add_u32 m0, s43, 114688
    s_nop 0
    buffer_load_dwordx4 v10, s[8:11], s40 offen lds
    v_mfma_f32_32x32x16_bf16 v[88:103], v[168:171], v[164:167], v[88:103]
    v_mfma_f32_32x32x16_bf16 v[104:119], v[172:175], v[164:167], v[104:119]
    s_add_u32 s40, s36, 245760
    s_add_u32 m0, s43, 122880
    s_nop 0
    buffer_load_dwordx4 v10, s[8:11], s40 offen lds
    s_waitcnt lgkmcnt(4)
    v_mfma_f32_32x32x16_bf16 v[56:71], v[184:187], v[176:179], v[56:71]
    v_mfma_f32_32x32x16_bf16 v[72:87], v[188:191], v[176:179], v[72:87]
    s_add_u32 s40, s37, 0
    s_add_u32 m0, s43, 131072
    s_nop 0
    buffer_load_dwordx4 v10, s[8:11], s40 offen lds
    v_mfma_f32_32x32x16_bf16 v[88:103], v[184:187], v[180:183], v[88:103]
    v_mfma_f32_32x32x16_bf16 v[104:119], v[188:191], v[180:183], v[104:119]
    s_add_u32 s40, s38, 0
    s_add_u32 m0, s43, 139264
    s_nop 0
    buffer_load_dwordx4 v10, s[8:11], s40 offen lds
    s_add_u32 s36, s36, 128
    s_add_u32 s37, s37, 128
    s_add_u32 s38, s38, 128
    s_waitcnt lgkmcnt(0)
    v_mfma_f32_32x32x16_bf16 v[56:71], v[200:203], v[192:195], v[56:71]
    v_mfma_f32_32x32x16_bf16 v[72:87], v[204:207], v[192:195], v[72:87]
    v_mfma_f32_32x32x16_bf16 v[88:103], v[200:203], v[196:199], v[88:103]
    v_mfma_f32_32x32x16_bf16 v[104:119], v[204:207], v[196:199], v[104:119]
    s_waitcnt vmcnt(6)
    s_barrier
    ds_read_b128 v[144:147], v120 offset:0
    ds_read_b128 v[148:151], v120 offset:4096
    ds_read_b128 v[152:155], v124 offset:0
    ds_read_b128 v[156:159], v124 offset:8192
    ds_read_b128 v[160:163], v121 offset:0
    ds_read_b128 v[164:167], v121 offset:4096
    ds_read_b128 v[168:171], v125 offset:0
    ds_read_b128 v[172:175], v125 offset:8192
    ds_read_b128 v[176:179], v122 offset:0
    ds_read_b128 v[180:183], v122 offset:4096
    ds_read_b128 v[184:187], v126 offset:0
    ds_read_b128 v[188:191], v126 offset:8192
    ds_read_b128 v[192:195], v123 offset:0
    ds_read_b128 v[196:199], v123 offset:4096
    ds_read_b128 v[200:203], v127 offset:0
    ds_read_b128 v[204:207], v127 offset:8192
    s_waitcnt lgkmcnt(12)
    v_mfma_f32_32x32x16_bf16 v[56:71], v[152:155], v[144:147], v[56:71]
    v_mfma_f32_32x32x16_bf16 v[72:87], v[156:159], v[144:147], v[72:87]
    s_add_u32 s40, s36, 0
    s_add_u32 m0, s43, 0
    s_nop 0
    buffer_load_dwordx4 v10, s[8:11], s40 offen lds
    v_mfma_f32_32x32x16_bf16 v[88:103], v[152:155], v[148:151], v[88:103]
    v_mfma_f32_32x32x16_bf16 v[104:119], v[156:159], v[148:151], v[104:119]
    s_add_u32 s40, s36, 81920
    s_add_u32 m0, s43, 8192
    s_nop 0
    buffer_load_dwordx4 v10, s[8:11], s40 offen lds
    s_waitcnt lgkmcnt(8)
    v_mfma_f32_32x32x16_bf16 v[56:71], v[168:171], v[160:163], v[56:71]
    v_mfma_f32_32x32x16_bf16 v[72:87], v[172:175], v[160:163], v[72:87]
    s_add_u32 s40, s36, 163840
    s_add_u32 m0, s43, 16384
    s_nop 0
    buffer_load_dwordx4 v10, s[8:11], s40 offen lds
    v_mfma_f32_32x32x16_bf16 v[88:103], v[168:171], v[164:167], v[88:103]
    v_mfma_f32_32x32x16_bf16 v[104:119], v[172:175], v[164:167], v[104:119]
    s_add_u32 s40, s36, 245760
    s_add_u32 m0, s43, 24576
    s_nop 0
    buffer_load_dwordx4 v10, s[8:11], s40 offen lds
    s_waitcnt lgkmcnt(4)
    v_mfma_f32_32x32x16_bf16 v[56:71], v[184:187], v[176:179], v[56:71]
    v_mfma_f32_32x32x16_bf16 v[72:87], v[188:191], v[176:179], v[72:87]
    s_add_u32 s40, s37, 0
    s_add_u32 m0, s43, 32768
    s_nop 0
    buffer_load_dwordx4 v10, s[8:11], s40 offen lds
    v_mfma_f32_32x32x16_bf16 v[88:103], v[184:187], v[180:183], v[88:103]
    v_mfma_f32_32x32x16_bf16 v[104:119], v[188:191], v[180:183], v[104:119]
    s_add_u32 s40, s38, 0
    s_add_u32 m0, s43, 40960
    s_nop 0
    buffer_load_dwordx4 v10, s[8:11], s40 offen lds
    s_add_u32 s36, s36, 128
    s_add_u32 s37, s37, 128
    s_add_u32 s38, s38, 128
    s_waitcnt lgkmcnt(0)
    v_mfma_f32_32x32x16_bf16 v[56:71], v[200:203], v[192:195], v[56:71]
    v_mfma_f32_32x32x16_bf16 v[72:87], v[204:207], v[192:195], v[72:87]
    v_mfma_f32_32x32x16_bf16 v[88:103], v[200:203], v[196:199], v[88:103]
    v_mfma_f32_32x32x16_bf16 v[104:119], v[204:207], v[196:199], v[104:119]
    s_waitcnt vmcnt(6)
    s_barrier
    ds_read_b128 v[144:147], v128 offset:0
    ds_read_b128 v[148:151], v128 offset:4096
    ds_read_b128 v[152:155], v132 offset:0
    ds_read_b128 v[156:159], v132 offset:8192
    ds_read_b128 v[160:163], v129 offset:0
    ds_read_b128 v[164:167], v129 offset:4096
    ds_read_b128 v[168:171], v133 offset:0
    ds_read_b128 v[172:175], v133 offset:8192
    ds_read_b128 v[176:179], v130 offset:0
    ds_read_b128 v[180:183], v130 offset:4096
    ds_read_b128 v[184:187], v134 offset:0
    ds_read_b128 v[188:191], v134 offset:8192
    ds_read_b128 v[192:195], v131 offset:0
    ds_read_b128 v[196:199], v131 offset:4096
    ds_read_b128 v[200:203], v135 offset:0
    ds_read_b128 v[204:207], v135 offset:8192
    s_waitcnt lgkmcnt(12)
    v_mfma_f32_32x32x16_bf16 v[56:71], v[152:155], v[144:147], v[56:71]
    v_mfma_f32_32x32x16_bf16 v[72:87], v[156:159], v[144:147], v[72:87]
    s_add_u32 s40, s36, 0
    s_add_u32 m0, s43, 49152
    s_nop 0
    buffer_load_dwordx4 v10, s[8:11], s40 offen lds
    v_mfma_f32_32x32x16_bf16 v[88:103], v[152:155], v[148:151], v[88:103]
    v_mfma_f32_32x32x16_bf16 v[104:119], v[156:159], v[148:151], v[104:119]
    s_add_u32 s40, s36, 81920
    s_add_u32 m0, s43, 57344
    s_nop 0
    buffer_load_dwordx4 v10, s[8:11], s40 offen lds
    s_waitcnt lgkmcnt(8)
    v_mfma_f32_32x32x16_bf16 v[56:71], v[168:171], v[160:163], v[56:71]
    v_mfma_f32_32x32x16_bf16 v[72:87], v[172:175], v[160:163], v[72:87]
    s_add_u32 s40, s36, 163840
    s_add_u32 m0, s43, 65536
    s_nop 0
    buffer_load_dwordx4 v10, s[8:11], s40 offen lds
    v_mfma_f32_32x32x16_bf16 v[88:103], v[168:171], v[164:167], v[88:103]
    v_mfma_f32_32x32x16_bf16 v[104:119], v[172:175], v[164:167], v[104:119]
    s_add_u32 s40, s36, 245760
    s_add_u32 m0, s43, 73728
    s_nop 0
    buffer_load_dwordx4 v10, s[8:11], s40 offen lds
    s_waitcnt lgkmcnt(4)
    v_mfma_f32_32x32x16_bf16 v[56:71], v[184:187], v[176:179], v[56:71]
    v_mfma_f32_32x32x16_bf16 v[72:87], v[188:191], v[176:179], v[72:87]
    s_add_u32 s40, s37, 0
    s_add_u32 m0, s43, 81920
    s_nop 0
    buffer_load_dwordx4 v10, s[8:11], s40 offen lds
    v_mfma_f32_32x32x16_bf16 v[88:103], v[184:187], v[180:183], v[88:103]
    v_mfma_f32_32x32x16_bf16 v[104:119], v[188:191], v[180:183], v[104:119]
    s_add_u32 s40, s38, 0
    s_add_u32 m0, s43, 90112
    s_nop 0
    buffer_load_dwordx4 v10, s[8:11], s40 offen lds
    s_add_u32 s36, s36, 128
    s_add_u32 s37, s37, 128
    s_add_u32 s38, s38, 128
    s_waitcnt lgkmcnt(0)
    v_mfma_f32_32x32x16_bf16 v[56:71], v[200:203], v[192:195], v[56:71]
    v_mfma_f32_32x32x16_bf16 v[72:87], v[204:207], v[192:195], v[72:87]
    v_mfma_f32_32x32x16_bf16 v[88:103], v[200:203], v[196:199], v[88:103]
    v_mfma_f32_32x32x16_bf16 v[104:119], v[204:207], v[196:199], v[104:119]
    s_waitcnt vmcnt(6)
    s_barrier
    ds_read_b128 v[144:147], v12 offset:0
    ds_read_b128 v[148:151], v12 offset:4096
    ds_read_b128 v[152:155], v16 offset:0
    ds_read_b128 v[156:159], v16 offset:8192
    ds_read_b128 v[160:163], v13 offset:0
    ds_read_b128 v[164:167], v13 offset:4096
    ds_read_b128 v[168:171], v17 offset:0
    ds_read_b128 v[172:175], v17 offset:8192
    ds_read_b128 v[176:179], v14 offset:0
    ds_read_b128 v[180:183], v14 offset:4096
    ds_read_b128 v[184:187], v18 offset:0
    ds_read_b128 v[188:191], v18 offset:8192
    ds_read_b128 v[192:195], v15 offset:0
    ds_read_b128 v[196:199], v15 offset:4096
    ds_read_b128 v[200:203], v19 offset:0
    ds_read_b128 v[204:207], v19 offset:8192
    s_waitcnt lgkmcnt(12)
    v_mfma_f32_32x32x16_bf16 v[56:71], v[152:155], v[144:147], v[56:71]
    v_mfma_f32_32x32x16_bf16 v[72:87], v[156:159], v[144:147], v[72:87]
    s_add_u32 s40, s36, 0
    s_add_u32 m0, s43, 98304
    s_nop 0
    buffer_load_dwordx4 v10, s[8:11], s40 offen lds
    v_mfma_f32_32x32x16_bf16 v[88:103], v[152:155], v[148:151], v[88:103]
    v_mfma_f32_32x32x16_bf16 v[104:119], v[156:159], v[148:151], v[104:119]
    s_add_u32 s40, s36, 81920
    s_add_u32 m0, s43, 106496
    s_nop 0
    buffer_load_dwordx4 v10, s[8:11], s40 offen lds
    s_waitcnt lgkmcnt(8)
    v_mfma_f32_32x32x16_bf16 v[56:71], v[168:171], v[160:163], v[56:71]
    v_mfma_f32_32x32x16_bf16 v[72:87], v[172:175], v[160:163], v[72:87]
    s_add_u32 s40, s36, 163840
    s_add_u32 m0, s43, 114688
    s_nop 0
    buffer_load_dwordx4 v10, s[8:11], s40 offen lds
    v_mfma_f32_32x32x16_bf16 v[88:103], v[168:171], v[164:167], v[88:103]
    v_mfma_f32_32x32x16_bf16 v[104:119], v[172:175], v[164:167], v[104:119]
    s_add_u32 s40, s36, 245760
    s_add_u32 m0, s43, 122880
    s_nop 0
    buffer_load_dwordx4 v10, s[8:11], s40 offen lds
    s_waitcnt lgkmcnt(4)
    v_mfma_f32_32x32x16_bf16 v[56:71], v[184:187], v[176:179], v[56:71]
    v_mfma_f32_32x32x16_bf16 v[72:87], v[188:191], v[176:179], v[72:87]
    s_add_u32 s40, s37, 0
    s_add_u32 m0, s43, 131072
    s_nop 0
    buffer_load_dwordx4 v10, s[8:11], s40 offen lds
    v_mfma_f32_32x32x16_bf16 v[88:103], v[184:187], v[180:183], v[88:103]
    v_mfma_f32_32x32x16_bf16 v[104:119], v[188:191], v[180:183], v[104:119]
    s_add_u32 s40, s38, 0
    s_add_u32 m0, s43, 139264
    s_nop 0
    buffer_load_dwordx4 v10, s[8:11], s40 offen lds
    s_add_u32 s36, s36, 128
    s_add_u32 s37, s37, 128
    s_add_u32 s38, s38, 128
    s_waitcnt lgkmcnt(0)
    v_mfma_f32_32x32x16_bf16 v[56:71], v[200:203], v[192:195], v[56:71]
    v_mfma_f32_32x32x16_bf16 v[72:87], v[204:207], v[192:195], v[72:87]
    v_mfma_f32_32x32x16_bf16 v[88:103], v[200:203], v[196:199], v[88:103]
    v_mfma_f32_32x32x16_bf16 v[104:119], v[204:207], v[196:199], v[104:119]
    s_waitcnt vmcnt(6)
    s_barrier
    ds_read_b128 v[144:147], v120 offset:0
    ds_read_b128 v[148:151], v120 offset:4096
    ds_read_b128 v[152:155], v124 offset:0
    ds_read_b128 v[156:159], v124 offset:8192
    ds_read_b128 v[160:163], v121 offset:0
    ds_read_b128 v[164:167], v121 offset:4096
    ds_read_b128 v[168:171], v125 offset:0
    ds_read_b128 v[172:175], v125 offset:8192
    ds_read_b128 v[176:179], v122 offset:0
    ds_read_b128 v[180:183], v122 offset:4096
    ds_read_b128 v[184:187], v126 offset:0
    ds_read_b128 v[188:191], v126 offset:8192
    ds_read_b128 v[192:195], v123 offset:0
    ds_read_b128 v[196:199], v123 offset:4096
    ds_read_b128 v[200:203], v127 offset:0
    ds_read_b128 v[204:207], v127 offset:8192
    s_waitcnt lgkmcnt(12)
    v_mfma_f32_32x32x16_bf16 v[56:71], v[152:155], v[144:147], v[56:71]
    v_mfma_f32_32x32x16_bf16 v[72:87], v[156:159], v[144:147], v[72:87]
    s_add_u32 s40, s36, 0
    s_add_u32 m0, s43, 0
    s_nop 0
    buffer_load_dwordx4 v10, s[8:11], s40 offen lds
    v_mfma_f32_32x32x16_bf16 v[88:103], v[152:155], v[148:151], v[88:103]
    v_mfma_f32_32x32x16_bf16 v[104:119], v[156:159], v[148:151], v[104:119]
    s_add_u32 s40, s36, 81920
    s_add_u32 m0, s43, 8192
    s_nop 0
    buffer_load_dwordx4 v10, s[8:11], s40 offen lds
    s_waitcnt lgkmcnt(8)
    v_mfma_f32_32x32x16_bf16 v[56:71], v[168:171], v[160:163], v[56:71]
    v_mfma_f32_32x32x16_bf16 v[72:87], v[172:175], v[160:163], v[72:87]
    s_add_u32 s40, s36, 163840
    s_add_u32 m0, s43, 16384
    s_nop 0
    buffer_load_dwordx4 v10, s[8:11], s40 offen lds
    v_mfma_f32_32x32x16_bf16 v[88:103], v[168:171], v[164:167], v[88:103]
    v_mfma_f32_32x32x16_bf16 v[104:119], v[172:175], v[164:167], v[104:119]
    s_add_u32 s40, s36, 245760
    s_add_u32 m0, s43, 24576
    s_nop 0
    buffer_load_dwordx4 v10, s[8:11], s40 offen lds
    s_waitcnt lgkmcnt(4)
    v_mfma_f32_32x32x16_bf16 v[56:71], v[184:187], v[176:179], v[56:71]
    v_mfma_f32_32x32x16_bf16 v[72:87], v[188:191], v[176:179], v[72:87]
    s_add_u32 s40, s37, 0
    s_add_u32 m0, s43, 32768
    s_nop 0
    buffer_load_dwordx4 v10, s[8:11], s40 offen lds
    v_mfma_f32_32x32x16_bf16 v[88:103], v[184:187], v[180:183], v[88:103]
    v_mfma_f32_32x32x16_bf16 v[104:119], v[188:191], v[180:183], v[104:119]
    s_add_u32 s40, s38, 0
    s_add_u32 m0, s43, 40960
    s_nop 0
    buffer_load_dwordx4 v10, s[8:11], s40 offen lds
    s_add_u32 s36, s36, 128
    s_add_u32 s37, s37, 128
    s_add_u32 s38, s38, 128
    s_waitcnt lgkmcnt(0)
    v_mfma_f32_32x32x16_bf16 v[56:71], v[200:203], v[192:195], v[56:71]
    v_mfma_f32_32x32x16_bf16 v[72:87], v[204:207], v[192:195], v[72:87]
    v_mfma_f32_32x32x16_bf16 v[88:103], v[200:203], v[196:199], v[88:103]
    v_mfma_f32_32x32x16_bf16 v[104:119], v[204:207], v[196:199], v[104:119]
    s_waitcnt vmcnt(6)
    s_barrier
    ds_read_b128 v[144:147], v128 offset:0
    ds_read_b128 v[148:151], v128 offset:4096
    ds_read_b128 v[152:155], v132 offset:0
    ds_read_b128 v[156:159], v132 offset:8192
    ds_read_b128 v[160:163], v129 offset:0
    ds_read_b128 v[164:167], v129 offset:4096
    ds_read_b128 v[168:171], v133 offset:0
    ds_read_b128 v[172:175], v133 offset:8192
    ds_read_b128 v[176:179], v130 offset:0
    ds_read_b128 v[180:183], v130 offset:4096
    ds_read_b128 v[184:187], v134 offset:0
    ds_read_b128 v[188:191], v134 offset:8192
    ds_read_b128 v[192:195], v131 offset:0
    ds_read_b128 v[196:199], v131 offset:4096
    ds_read_b128 v[200:203], v135 offset:0
    ds_read_b128 v[204:207], v135 offset:8192
    s_waitcnt lgkmcnt(12)
    v_mfma_f32_32x32x16_bf16 v[56:71], v[152:155], v[144:147], v[56:71]
    v_mfma_f32_32x32x16_bf16 v[72:87], v[156:159], v[144:147], v[72:87]
    v_mfma_f32_32x32x16_bf16 v[88:103], v[152:155], v[148:151], v[88:103]
    v_mfma_f32_32x32x16_bf16 v[104:119], v[156:159], v[148:151], v[104:119]
    s_waitcnt lgkmcnt(8)
    v_mfma_f32_32x32x16_bf16 v[56:71], v[168:171], v[160:163], v[56:71]
    v_mfma_f32_32x32x16_bf16 v[72:87], v[172:175], v[160:163], v[72:87]
    v_mfma_f32_32x32x16_bf16 v[88:103], v[168:171], v[164:167], v[88:103]
    v_mfma_f32_32x32x16_bf16 v[104:119], v[172:175], v[164:167], v[104:119]
    s_waitcnt lgkmcnt(4)
    v_mfma_f32_32x32x16_bf16 v[56:71], v[184:187], v[176:179], v[56:71]
    v_mfma_f32_32x32x16_bf16 v[72:87], v[188:191], v[176:179], v[72:87]
    v_mfma_f32_32x32x16_bf16 v[88:103], v[184:187], v[180:183], v[88:103]
    v_mfma_f32_32x32x16_bf16 v[104:119], v[188:191], v[180:183], v[104:119]
    s_waitcnt lgkmcnt(0)
    v_mfma_f32_32x32x16_bf16 v[56:71], v[200:203], v[192:195], v[56:71]
    v_mfma_f32_32x32x16_bf16 v[72:87], v[204:207], v[192:195], v[72:87]
    v_mfma_f32_32x32x16_bf16 v[88:103], v[200:203], v[196:199], v[88:103]
    v_mfma_f32_32x32x16_bf16 v[104:119], v[204:207], v[196:199], v[104:119]
    s_waitcnt vmcnt(0)
    s_barrier
    ds_read_b128 v[144:147], v12 offset:0
    ds_read_b128 v[148:151], v12 offset:4096
    ds_read_b128 v[152:155], v16 offset:0
    ds_read_b128 v[156:159], v16 offset:8192
    ds_read_b128 v[160:163], v13 offset:0
    ds_read_b128 v[164:167], v13 offset:4096
    ds_read_b128 v[168:171], v17 offset:0
    ds_read_b128 v[172:175], v17 offset:8192
    ds_read_b128 v[176:179], v14 offset:0
    ds_read_b128 v[180:183], v14 offset:4096
    ds_read_b128 v[184:187], v18 offset:0
    ds_read_b128 v[188:191], v18 offset:8192
    ds_read_b128 v[192:195], v15 offset:0
    ds_read_b128 v[196:199], v15 offset:4096
    ds_read_b128 v[200:203], v19 offset:0
    ds_read_b128 v[204:207], v19 offset:8192
    s_waitcnt lgkmcnt(12)
    v_mfma_f32_32x32x16_bf16 v[56:71], v[152:155], v[144:147], v[56:71]
    v_mfma_f32_32x32x16_bf16 v[72:87], v[156:159], v[144:147], v[72:87]
    v_mfma_f32_32x32x16_bf16 v[88:103], v[152:155], v[148:151], v[88:103]
    v_mfma_f32_32x32x16_bf16 v[104:119], v[156:159], v[148:151], v[104:119]
    s_waitcnt lgkmcnt(8)
    v_mfma_f32_32x32x16_bf16 v[56:71], v[168:171], v[160:163], v[56:71]
    v_mfma_f32_32x32x16_bf16 v[72:87], v[172:175], v[160:163], v[72:87]
    v_mfma_f32_32x32x16_bf16 v[88:103], v[168:171], v[164:167], v[88:103]
    v_mfma_f32_32x32x16_bf16 v[104:119], v[172:175], v[164:167], v[104:119]
    s_waitcnt lgkmcnt(4)
    v_mfma_f32_32x32x16_bf16 v[56:71], v[184:187], v[176:179], v[56:71]
    v_mfma_f32_32x32x16_bf16 v[72:87], v[188:191], v[176:179], v[72:87]
    v_mfma_f32_32x32x16_bf16 v[88:103], v[184:187], v[180:183], v[88:103]
    v_mfma_f32_32x32x16_bf16 v[104:119], v[188:191], v[180:183], v[104:119]
    s_waitcnt lgkmcnt(0)
    v_mfma_f32_32x32x16_bf16 v[56:71], v[200:203], v[192:195], v[56:71]
    v_mfma_f32_32x32x16_bf16 v[72:87], v[204:207], v[192:195], v[72:87]
    v_mfma_f32_32x32x16_bf16 v[88:103], v[200:203], v[196:199], v[88:103]
    v_mfma_f32_32x32x16_bf16 v[104:119], v[204:207], v[196:199], v[104:119]
    s_nop 15
    s_nop 3
    s_mul_i32 s36, s34, 884736
    s_lshl_b32 s37, s35, 7
    s_add_u32 s36, s36, s37
    s_add_u32 s36, s36, 20971520
    v_lshl_add_u32 v7, v5, 6, v3
    v_mul_u32_u24 v7, 3456, v7
    v_lshl_add_u32 v7, v6, 6, v7
    v_lshl_add_u32 v7, v4, 3, v7
    v_mov_b32 v23, 0x3dd2d3e8
    v_mov_b32 v22, 0x40135761
    v_cvt_pk_bf16_f32 v24, v56, v56
    v_lshlrev_b32 v24, 16, v24
    v_cvt_pk_bf16_f32 v25, v72, v72
    v_lshlrev_b32 v25, 16, v25
    v_mul_f32 v26, v24, v24
    v_fma_f32 v26, v26, v23, v22
    v_mul_f32 v26, v26, v24
    v_exp_f32 v26, v26
    v_cvt_pk_bf16_f32 v28, v57, v57
    v_lshlrev_b32 v28, 16, v28
    v_cvt_pk_bf16_f32 v29, v73, v73
    v_lshlrev_b32 v29, 16, v29
    v_mul_f32 v30, v28, v28
    v_fma_f32 v30, v30, v23, v22
    v_mul_f32 v30, v30, v28
    v_exp_f32 v30, v30
    v_cvt_pk_bf16_f32 v32, v58, v58
    v_lshlrev_b32 v32, 16, v32
    v_cvt_pk_bf16_f32 v33, v74, v74
    v_lshlrev_b32 v33, 16, v33
    v_mul_f32 v34, v32, v32
    v_fma_f32 v34, v34, v23, v22
    v_mul_f32 v34, v34, v32
    v_exp_f32 v34, v34
    v_cvt_pk_bf16_f32 v36, v59, v59
    v_lshlrev_b32 v36, 16, v36
    v_cvt_pk_bf16_f32 v37, v75, v75
    v_lshlrev_b32 v37, 16, v37
    v_mul_f32 v38, v36, v36
    v_fma_f32 v38, v38, v23, v22
    v_mul_f32 v38, v38, v36
    v_exp_f32 v38, v38
    v_add_f32 v26, 1.0, v26
    v_rcp_f32 v26, v26
    v_add_f32 v30, 1.0, v30
    v_rcp_f32 v30, v30
    v_add_f32 v34, 1.0, v34
    v_rcp_f32 v34, v34
    v_add_f32 v38, 1.0, v38
    v_rcp_f32 v38, v38
    v_fma_f32 v26, -v24, v26, v24
    v_cvt_pk_bf16_f32 v26, v26, v26
    v_lshlrev_b32 v26, 16, v26
    v_mul_f32 v26, v26, v25
    v_fma_f32 v30, -v28, v30, v28
    v_cvt_pk_bf16_f32 v30, v30, v30
    v_lshlrev_b32 v30, 16, v30
    v_mul_f32 v30, v30, v29
    v_fma_f32 v34, -v32, v34, v32
    v_cvt_pk_bf16_f32 v34, v34, v34
    v_lshlrev_b32 v34, 16, v34
    v_mul_f32 v34, v34, v33
    v_fma_f32 v38, -v36, v38, v36
    v_cvt_pk_bf16_f32 v38, v38, v38
    v_lshlrev_b32 v38, 16, v38
    v_mul_f32 v38, v38, v37
    v_cvt_pk_bf16_f32 v40, v26, v30
    v_cvt_pk_bf16_f32 v41, v34, v38
    s_add_u32 s37, s36, 0
    buffer_store_dwordx2 v[40:41], v7, s[8:11], s37 offen offset:0
    v_cvt_pk_bf16_f32 v24, v60, v60
    v_lshlrev_b32 v24, 16, v24
    v_cvt_pk_bf16_f32 v25, v76, v76
    v_lshlrev_b32 v25, 16, v25
    v_mul_f32 v26, v24, v24
    v_fma_f32 v26, v26, v23, v22
    v_mul_f32 v26, v26, v24
    v_exp_f32 v26, v26
    v_cvt_pk_bf16_f32 v28, v61, v61
    v_lshlrev_b32 v28, 16, v28
    v_cvt_pk_bf16_f32 v29, v77, v77
    v_lshlrev_b32 v29, 16, v29
    v_mul_f32 v30, v28, v28
    v_fma_f32 v30, v30, v23, v22
    v_mul_f32 v30, v30, v28
    v_exp_f32 v30, v30
    v_cvt_pk_bf16_f32 v32, v62, v62
    v_lshlrev_b32 v32, 16, v32
    v_cvt_pk_bf16_f32 v33, v78, v78
    v_lshlrev_b32 v33, 16, v33
    v_mul_f32 v34, v32, v32
    v_fma_f32 v34, v34, v23, v22
    v_mul_f32 v34, v34, v32
    v_exp_f32 v34, v34
    v_cvt_pk_bf16_f32 v36, v63, v63
    v_lshlrev_b32 v36, 16, v36
    v_cvt_pk_bf16_f32 v37, v79, v79
    v_lshlrev_b32 v37, 16, v37
    v_mul_f32 v38, v36, v36
    v_fma_f32 v38, v38, v23, v22
    v_mul_f32 v38, v38, v36
    v_exp_f32 v38, v38
    v_add_f32 v26, 1.0, v26
    v_rcp_f32 v26, v26
    v_add_f32 v30, 1.0, v30
    v_rcp_f32 v30, v30
    v_add_f32 v34, 1.0, v34
    v_rcp_f32 v34, v34
    v_add_f32 v38, 1.0, v38
    v_rcp_f32 v38, v38
    v_fma_f32 v26, -v24, v26, v24
    v_cvt_pk_bf16_f32 v26, v26, v26
    v_lshlrev_b32 v26, 16, v26
    v_mul_f32 v26, v26, v25
    v_fma_f32 v30, -v28, v30, v28
    v_cvt_pk_bf16_f32 v30, v30, v30
    v_lshlrev_b32 v30, 16, v30
    v_mul_f32 v30, v30, v29
    v_fma_f32 v34, -v32, v34, v32
    v_cvt_pk_bf16_f32 v34, v34, v34
    v_lshlrev_b32 v34, 16, v34
    v_mul_f32 v34, v34, v33
    v_fma_f32 v38, -v36, v38, v36
    v_cvt_pk_bf16_f32 v38, v38, v38
    v_lshlrev_b32 v38, 16, v38
    v_mul_f32 v38, v38, v37
    v_cvt_pk_bf16_f32 v42, v26, v30
    v_cvt_pk_bf16_f32 v43, v34, v38
    s_add_u32 s37, s36, 0
    buffer_store_dwordx2 v[42:43], v7, s[8:11], s37 offen offset:16
    v_cvt_pk_bf16_f32 v24, v64, v64
    v_lshlrev_b32 v24, 16, v24
    v_cvt_pk_bf16_f32 v25, v80, v80
    v_lshlrev_b32 v25, 16, v25
    v_mul_f32 v26, v24, v24
    v_fma_f32 v26, v26, v23, v22
    v_mul_f32 v26, v26, v24
    v_exp_f32 v26, v26
    v_cvt_pk_bf16_f32 v28, v65, v65
    v_lshlrev_b32 v28, 16, v28
    v_cvt_pk_bf16_f32 v29, v81, v81
    v_lshlrev_b32 v29, 16, v29
    v_mul_f32 v30, v28, v28
    v_fma_f32 v30, v30, v23, v22
    v_mul_f32 v30, v30, v28
    v_exp_f32 v30, v30
    v_cvt_pk_bf16_f32 v32, v66, v66
    v_lshlrev_b32 v32, 16, v32
    v_cvt_pk_bf16_f32 v33, v82, v82
    v_lshlrev_b32 v33, 16, v33
    v_mul_f32 v34, v32, v32
    v_fma_f32 v34, v34, v23, v22
    v_mul_f32 v34, v34, v32
    v_exp_f32 v34, v34
    v_cvt_pk_bf16_f32 v36, v67, v67
    v_lshlrev_b32 v36, 16, v36
    v_cvt_pk_bf16_f32 v37, v83, v83
    v_lshlrev_b32 v37, 16, v37
    v_mul_f32 v38, v36, v36
    v_fma_f32 v38, v38, v23, v22
    v_mul_f32 v38, v38, v36
    v_exp_f32 v38, v38
    v_add_f32 v26, 1.0, v26
    v_rcp_f32 v26, v26
    v_add_f32 v30, 1.0, v30
    v_rcp_f32 v30, v30
    v_add_f32 v34, 1.0, v34
    v_rcp_f32 v34, v34
    v_add_f32 v38, 1.0, v38
    v_rcp_f32 v38, v38
    v_fma_f32 v26, -v24, v26, v24
    v_cvt_pk_bf16_f32 v26, v26, v26
    v_lshlrev_b32 v26, 16, v26
    v_mul_f32 v26, v26, v25
    v_fma_f32 v30, -v28, v30, v28
    v_cvt_pk_bf16_f32 v30, v30, v30
    v_lshlrev_b32 v30, 16, v30
    v_mul_f32 v30, v30, v29
    v_fma_f32 v34, -v32, v34, v32
    v_cvt_pk_bf16_f32 v34, v34, v34
    v_lshlrev_b32 v34, 16, v34
    v_mul_f32 v34, v34, v33
    v_fma_f32 v38, -v36, v38, v36
    v_cvt_pk_bf16_f32 v38, v38, v38
    v_lshlrev_b32 v38, 16, v38
    v_mul_f32 v38, v38, v37
    v_cvt_pk_bf16_f32 v40, v26, v30
    v_cvt_pk_bf16_f32 v41, v34, v38
    s_add_u32 s37, s36, 0
    buffer_store_dwordx2 v[40:41], v7, s[8:11], s37 offen offset:32
    v_cvt_pk_bf16_f32 v24, v68, v68
    v_lshlrev_b32 v24, 16, v24
    v_cvt_pk_bf16_f32 v25, v84, v84
    v_lshlrev_b32 v25, 16, v25
    v_mul_f32 v26, v24, v24
    v_fma_f32 v26, v26, v23, v22
    v_mul_f32 v26, v26, v24
    v_exp_f32 v26, v26
    v_cvt_pk_bf16_f32 v28, v69, v69
    v_lshlrev_b32 v28, 16, v28
    v_cvt_pk_bf16_f32 v29, v85, v85
    v_lshlrev_b32 v29, 16, v29
    v_mul_f32 v30, v28, v28
    v_fma_f32 v30, v30, v23, v22
    v_mul_f32 v30, v30, v28
    v_exp_f32 v30, v30
    v_cvt_pk_bf16_f32 v32, v70, v70
    v_lshlrev_b32 v32, 16, v32
    v_cvt_pk_bf16_f32 v33, v86, v86
    v_lshlrev_b32 v33, 16, v33
    v_mul_f32 v34, v32, v32
    v_fma_f32 v34, v34, v23, v22
    v_mul_f32 v34, v34, v32
    v_exp_f32 v34, v34
    v_cvt_pk_bf16_f32 v36, v71, v71
    v_lshlrev_b32 v36, 16, v36
    v_cvt_pk_bf16_f32 v37, v87, v87
    v_lshlrev_b32 v37, 16, v37
    v_mul_f32 v38, v36, v36
    v_fma_f32 v38, v38, v23, v22
    v_mul_f32 v38, v38, v36
    v_exp_f32 v38, v38
    v_add_f32 v26, 1.0, v26
    v_rcp_f32 v26, v26
    v_add_f32 v30, 1.0, v30
    v_rcp_f32 v30, v30
    v_add_f32 v34, 1.0, v34
    v_rcp_f32 v34, v34
    v_add_f32 v38, 1.0, v38
    v_rcp_f32 v38, v38
    v_fma_f32 v26, -v24, v26, v24
    v_cvt_pk_bf16_f32 v26, v26, v26
    v_lshlrev_b32 v26, 16, v26
    v_mul_f32 v26, v26, v25
    v_fma_f32 v30, -v28, v30, v28
    v_cvt_pk_bf16_f32 v30, v30, v30
    v_lshlrev_b32 v30, 16, v30
    v_mul_f32 v30, v30, v29
    v_fma_f32 v34, -v32, v34, v32
    v_cvt_pk_bf16_f32 v34, v34, v34
    v_lshlrev_b32 v34, 16, v34
    v_mul_f32 v34, v34, v33
    v_fma_f32 v38, -v36, v38, v36
    v_cvt_pk_bf16_f32 v38, v38, v38
    v_lshlrev_b32 v38, 16, v38
    v_mul_f32 v38, v38, v37
    v_cvt_pk_bf16_f32 v42, v26, v30
    v_cvt_pk_bf16_f32 v43, v34, v38
    s_add_u32 s37, s36, 0
    buffer_store_dwordx2 v[42:43], v7, s[8:11], s37 offen offset:48
    v_cvt_pk_bf16_f32 v24, v88, v88
    v_lshlrev_b32 v24, 16, v24
    v_cvt_pk_bf16_f32 v25, v104, v104
    v_lshlrev_b32 v25, 16, v25
    v_mul_f32 v26, v24, v24
    v_fma_f32 v26, v26, v23, v22
    v_mul_f32 v26, v26, v24
    v_exp_f32 v26, v26
    v_cvt_pk_bf16_f32 v28, v89, v89
    v_lshlrev_b32 v28, 16, v28
    v_cvt_pk_bf16_f32 v29, v105, v105
    v_lshlrev_b32 v29, 16, v29
    v_mul_f32 v30, v28, v28
    v_fma_f32 v30, v30, v23, v22
    v_mul_f32 v30, v30, v28
    v_exp_f32 v30, v30
    v_cvt_pk_bf16_f32 v32, v90, v90
    v_lshlrev_b32 v32, 16, v32
    v_cvt_pk_bf16_f32 v33, v106, v106
    v_lshlrev_b32 v33, 16, v33
    v_mul_f32 v34, v32, v32
    v_fma_f32 v34, v34, v23, v22
    v_mul_f32 v34, v34, v32
    v_exp_f32 v34, v34
    v_cvt_pk_bf16_f32 v36, v91, v91
    v_lshlrev_b32 v36, 16, v36
    v_cvt_pk_bf16_f32 v37, v107, v107
    v_lshlrev_b32 v37, 16, v37
    v_mul_f32 v38, v36, v36
    v_fma_f32 v38, v38, v23, v22
    v_mul_f32 v38, v38, v36
    v_exp_f32 v38, v38
    v_add_f32 v26, 1.0, v26
    v_rcp_f32 v26, v26
    v_add_f32 v30, 1.0, v30
    v_rcp_f32 v30, v30
    v_add_f32 v34, 1.0, v34
    v_rcp_f32 v34, v34
    v_add_f32 v38, 1.0, v38
    v_rcp_f32 v38, v38
    v_fma_f32 v26, -v24, v26, v24
    v_cvt_pk_bf16_f32 v26, v26, v26
    v_lshlrev_b32 v26, 16, v26
    v_mul_f32 v26, v26, v25
    v_fma_f32 v30, -v28, v30, v28
    v_cvt_pk_bf16_f32 v30, v30, v30
    v_lshlrev_b32 v30, 16, v30
    v_mul_f32 v30, v30, v29
    v_fma_f32 v34, -v32, v34, v32
    v_cvt_pk_bf16_f32 v34, v34, v34
    v_lshlrev_b32 v34, 16, v34
    v_mul_f32 v34, v34, v33
    v_fma_f32 v38, -v36, v38, v36
    v_cvt_pk_bf16_f32 v38, v38, v38
    v_lshlrev_b32 v38, 16, v38
    v_mul_f32 v38, v38, v37
    v_cvt_pk_bf16_f32 v40, v26, v30
    v_cvt_pk_bf16_f32 v41, v34, v38
    s_add_u32 s37, s36, 110592
    buffer_store_dwordx2 v[40:41], v7, s[8:11], s37 offen offset:0
    v_cvt_pk_bf16_f32 v24, v92, v92
    v_lshlrev_b32 v24, 16, v24
    v_cvt_pk_bf16_f32 v25, v108, v108
    v_lshlrev_b32 v25, 16, v25
    v_mul_f32 v26, v24, v24
    v_fma_f32 v26, v26, v23, v22
    v_mul_f32 v26, v26, v24
    v_exp_f32 v26, v26
    v_cvt_pk_bf16_f32 v28, v93, v93
    v_lshlrev_b32 v28, 16, v28
    v_cvt_pk_bf16_f32 v29, v109, v109
    v_lshlrev_b32 v29, 16, v29
    v_mul_f32 v30, v28, v28
    v_fma_f32 v30, v30, v23, v22
    v_mul_f32 v30, v30, v28
    v_exp_f32 v30, v30
    v_cvt_pk_bf16_f32 v32, v94, v94
    v_lshlrev_b32 v32, 16, v32
    v_cvt_pk_bf16_f32 v33, v110, v110
    v_lshlrev_b32 v33, 16, v33
    v_mul_f32 v34, v32, v32
    v_fma_f32 v34, v34, v23, v22
    v_mul_f32 v34, v34, v32
    v_exp_f32 v34, v34
    v_cvt_pk_bf16_f32 v36, v95, v95
    v_lshlrev_b32 v36, 16, v36
    v_cvt_pk_bf16_f32 v37, v111, v111
    v_lshlrev_b32 v37, 16, v37
    v_mul_f32 v38, v36, v36
    v_fma_f32 v38, v38, v23, v22
    v_mul_f32 v38, v38, v36
    v_exp_f32 v38, v38
    v_add_f32 v26, 1.0, v26
    v_rcp_f32 v26, v26
    v_add_f32 v30, 1.0, v30
    v_rcp_f32 v30, v30
    v_add_f32 v34, 1.0, v34
    v_rcp_f32 v34, v34
    v_add_f32 v38, 1.0, v38
    v_rcp_f32 v38, v38
    v_fma_f32 v26, -v24, v26, v24
    v_cvt_pk_bf16_f32 v26, v26, v26
    v_lshlrev_b32 v26, 16, v26
    v_mul_f32 v26, v26, v25
    v_fma_f32 v30, -v28, v30, v28
    v_cvt_pk_bf16_f32 v30, v30, v30
    v_lshlrev_b32 v30, 16, v30
    v_mul_f32 v30, v30, v29
    v_fma_f32 v34, -v32, v34, v32
    v_cvt_pk_bf16_f32 v34, v34, v34
    v_lshlrev_b32 v34, 16, v34
    v_mul_f32 v34, v34, v33
    v_fma_f32 v38, -v36, v38, v36
    v_cvt_pk_bf16_f32 v38, v38, v38
    v_lshlrev_b32 v38, 16, v38
    v_mul_f32 v38, v38, v37
    v_cvt_pk_bf16_f32 v42, v26, v30
    v_cvt_pk_bf16_f32 v43, v34, v38
    s_add_u32 s37, s36, 110592
    buffer_store_dwordx2 v[42:43], v7, s[8:11], s37 offen offset:16
    v_cvt_pk_bf16_f32 v24, v96, v96
    v_lshlrev_b32 v24, 16, v24
    v_cvt_pk_bf16_f32 v25, v112, v112
    v_lshlrev_b32 v25, 16, v25
    v_mul_f32 v26, v24, v24
    v_fma_f32 v26, v26, v23, v22
    v_mul_f32 v26, v26, v24
    v_exp_f32 v26, v26
    v_cvt_pk_bf16_f32 v28, v97, v97
    v_lshlrev_b32 v28, 16, v28
    v_cvt_pk_bf16_f32 v29, v113, v113
    v_lshlrev_b32 v29, 16, v29
    v_mul_f32 v30, v28, v28
    v_fma_f32 v30, v30, v23, v22
    v_mul_f32 v30, v30, v28
    v_exp_f32 v30, v30
    v_cvt_pk_bf16_f32 v32, v98, v98
    v_lshlrev_b32 v32, 16, v32
    v_cvt_pk_bf16_f32 v33, v114, v114
    v_lshlrev_b32 v33, 16, v33
    v_mul_f32 v34, v32, v32
    v_fma_f32 v34, v34, v23, v22
    v_mul_f32 v34, v34, v32
    v_exp_f32 v34, v34
    v_cvt_pk_bf16_f32 v36, v99, v99
    v_lshlrev_b32 v36, 16, v36
    v_cvt_pk_bf16_f32 v37, v115, v115
    v_lshlrev_b32 v37, 16, v37
    v_mul_f32 v38, v36, v36
    v_fma_f32 v38, v38, v23, v22
    v_mul_f32 v38, v38, v36
    v_exp_f32 v38, v38
    v_add_f32 v26, 1.0, v26
    v_rcp_f32 v26, v26
    v_add_f32 v30, 1.0, v30
    v_rcp_f32 v30, v30
    v_add_f32 v34, 1.0, v34
    v_rcp_f32 v34, v34
    v_add_f32 v38, 1.0, v38
    v_rcp_f32 v38, v38
    v_fma_f32 v26, -v24, v26, v24
    v_cvt_pk_bf16_f32 v26, v26, v26
    v_lshlrev_b32 v26, 16, v26
    v_mul_f32 v26, v26, v25
    v_fma_f32 v30, -v28, v30, v28
    v_cvt_pk_bf16_f32 v30, v30, v30
    v_lshlrev_b32 v30, 16, v30
    v_mul_f32 v30, v30, v29
    v_fma_f32 v34, -v32, v34, v32
    v_cvt_pk_bf16_f32 v34, v34, v34
    v_lshlrev_b32 v34, 16, v34
    v_mul_f32 v34, v34, v33
    v_fma_f32 v38, -v36, v38, v36
    v_cvt_pk_bf16_f32 v38, v38, v38
    v_lshlrev_b32 v38, 16, v38
    v_mul_f32 v38, v38, v37
    v_cvt_pk_bf16_f32 v40, v26, v30
    v_cvt_pk_bf16_f32 v41, v34, v38
    s_add_u32 s37, s36, 110592
    buffer_store_dwordx2 v[40:41], v7, s[8:11], s37 offen offset:32
    v_cvt_pk_bf16_f32 v24, v100, v100
    v_lshlrev_b32 v24, 16, v24
    v_cvt_pk_bf16_f32 v25, v116, v116
    v_lshlrev_b32 v25, 16, v25
    v_mul_f32 v26, v24, v24
    v_fma_f32 v26, v26, v23, v22
    v_mul_f32 v26, v26, v24
    v_exp_f32 v26, v26
    v_cvt_pk_bf16_f32 v28, v101, v101
    v_lshlrev_b32 v28, 16, v28
    v_cvt_pk_bf16_f32 v29, v117, v117
    v_lshlrev_b32 v29, 16, v29
    v_mul_f32 v30, v28, v28
    v_fma_f32 v30, v30, v23, v22
    v_mul_f32 v30, v30, v28
    v_exp_f32 v30, v30
    v_cvt_pk_bf16_f32 v32, v102, v102
    v_lshlrev_b32 v32, 16, v32
    v_cvt_pk_bf16_f32 v33, v118, v118
    v_lshlrev_b32 v33, 16, v33
    v_mul_f32 v34, v32, v32
    v_fma_f32 v34, v34, v23, v22
    v_mul_f32 v34, v34, v32
    v_exp_f32 v34, v34
    v_cvt_pk_bf16_f32 v36, v103, v103
    v_lshlrev_b32 v36, 16, v36
    v_cvt_pk_bf16_f32 v37, v119, v119
    v_lshlrev_b32 v37, 16, v37
    v_mul_f32 v38, v36, v36
    v_fma_f32 v38, v38, v23, v22
    v_mul_f32 v38, v38, v36
    v_exp_f32 v38, v38
    v_add_f32 v26, 1.0, v26
    v_rcp_f32 v26, v26
    v_add_f32 v30, 1.0, v30
    v_rcp_f32 v30, v30
    v_add_f32 v34, 1.0, v34
    v_rcp_f32 v34, v34
    v_add_f32 v38, 1.0, v38
    v_rcp_f32 v38, v38
    v_fma_f32 v26, -v24, v26, v24
    v_cvt_pk_bf16_f32 v26, v26, v26
    v_lshlrev_b32 v26, 16, v26
    v_mul_f32 v26, v26, v25
    v_fma_f32 v30, -v28, v30, v28
    v_cvt_pk_bf16_f32 v30, v30, v30
    v_lshlrev_b32 v30, 16, v30
    v_mul_f32 v30, v30, v29
    v_fma_f32 v34, -v32, v34, v32
    v_cvt_pk_bf16_f32 v34, v34, v34
    v_lshlrev_b32 v34, 16, v34
    v_mul_f32 v34, v34, v33
    v_fma_f32 v38, -v36, v38, v36
    v_cvt_pk_bf16_f32 v38, v38, v38
    v_lshlrev_b32 v38, 16, v38
    v_mul_f32 v38, v38, v37
    v_cvt_pk_bf16_f32 v42, v26, v30
    v_cvt_pk_bf16_f32 v43, v34, v38
    s_add_u32 s37, s36, 110592
    buffer_store_dwordx2 v[42:43], v7, s[8:11], s37 offen offset:48
gemm1_kernel_end:
    s_endpgm
.globl gemm2_kernel
.p2align 8
.type gemm2_kernel,@function
gemm2_kernel:
    s_cmp_ge_u32 s2, 160
    s_cbranch_scc1 gemm2_kernel_end
    s_load_dwordx2 s[22:23], s[0:1], 88
    s_load_dwordx2 s[24:25], s[0:1], 104
    s_waitcnt lgkmcnt(0)
    s_mov_b32 s8, s24
    s_mov_b32 s9, s25
    s_mov_b32 s10, 67108864
    s_mov_b32 s11, 0x00020000
    s_mov_b32 s28, s22
    s_mov_b32 s29, s23
    s_mov_b32 s30, 2621440
    s_mov_b32 s31, 0x00020000
    s_and_b32 s33, s2, 7
    s_mul_i32 s33, s33, 20
    s_lshr_b32 s2, s2, 3
    s_add_u32 s2, s2, s33
    s_mov_b32 s33, 858993460
    s_mul_hi_u32 s34, s2, s33
    s_mul_i32 s35, s34, 5
    s_sub_u32 s35, s2, s35
    v_and_b32 v1, 63, v0
    v_lshrrev_b32 v2, 6, v0
    v_and_b32 v3, 31, v0
    v_lshrrev_b32 v4, 5, v1
    v_lshrrev_b32 v5, 1, v2
    v_and_b32 v6, 1, v2
    v_mov_b32 v11, v6
    v_and_b32 v5, 1, v2
    v_lshrrev_b32 v6, 1, v2
    s_nop 0
    v_readfirstlane_b32 s41, v2
    s_mul_i32 s36, s34, 221184
    s_add_u32 s36, s36, 20971520
    v_lshrrev_b32 v7, 4, v1
    v_lshl_add_u32 v7, v11, 2, v7
    v_and_b32 v8, 7, v1
    v_xor_b32 v7, v7, v8
    v_lshrrev_b32 v8, 3, v1
    v_mul_u32_u24 v10, 3456, v8
    v_lshl_add_u32 v10, v7, 4, v10
    s_mul_i32 s37, s35, 442368
    s_add_u32 s37, s37, 37748736
    s_add_u32 s38, s37, 221184
    s_mul_i32 s42, s41, 27648
    s_add_u32 s36, s36, s42
    s_add_u32 s37, s37, s42
    s_add_u32 s38, s38, s42
    s_lshl_b32 s43, s41, 10
    v_lshrrev_b32 v7, 1, v3
    v_and_b32 v7, 7, v7
    v_lshlrev_b32 v8, 7, v3
    v_add_u32 v9, 0, v4
    v_xor_b32 v9, v9, v7
    v_lshl_add_u32 v9, v9, 4, v8
    v_mul_u32_u24 v12, 4096, v5
    v_add_u32 v12, v12, v9
    v_mul_u32_u24 v16, 4096, v6
    v_add_u32 v16, v16, v9
    v_add_u32 v16, 8192, v16
    v_add_u32 v9, 2, v4
    v_xor_b32 v9, v9, v7
    v_lshl_add_u32 v9, v9, 4, v8
    v_mul_u32_u24 v13, 4096, v5
    v_add_u32 v13, v13, v9
    v_mul_u32_u24 v17, 4096, v6
    v_add_u32 v17, v17, v9
    v_add_u32 v17, 8192, v17
    v_add_u32 v9, 4, v4
    v_xor_b32 v9, v9, v7
    v_lshl_add_u32 v9, v9, 4, v8
    v_mul_u32_u24 v14, 4096, v5
    v_add_u32 v14, v14, v9
    v_mul_u32_u24 v18, 4096, v6
    v_add_u32 v18, v18, v9
    v_add_u32 v18, 8192, v18
    v_add_u32 v9, 6, v4
    v_xor_b32 v9, v9, v7
    v_lshl_add_u32 v9, v9, 4, v8
    v_mul_u32_u24 v15, 4096, v5
    v_add_u32 v15, v15, v9
    v_mul_u32_u24 v19, 4096, v6
    v_add_u32 v19, v19, v9
    v_add_u32 v19, 8192, v19
    v_mov_b32 v56, 0
    v_mov_b32 v57, 0
    v_mov_b32 v58, 0
    v_mov_b32 v59, 0
    v_mov_b32 v60, 0
    v_mov_b32 v61, 0
    v_mov_b32 v62, 0
    v_mov_b32 v63, 0
    v_mov_b32 v64, 0
    v_mov_b32 v65, 0
    v_mov_b32 v66, 0
    v_mov_b32 v67, 0
    v_mov_b32 v68, 0
    v_mov_b32 v69, 0
    v_mov_b32 v70, 0
    v_mov_b32 v71, 0
    v_add_u32 v88, 24576, v12
    v_add_u32 v89, 24576, v13
    v_add_u32 v90, 24576, v14
    v_add_u32 v91, 24576, v15
    v_add_u32 v92, 24576, v16
    v_add_u32 v93, 24576, v17
    v_add_u32 v94, 24576, v18
    v_add_u32 v95, 24576, v19
    v_add_u32 v96, 49152, v12
    v_add_u32 v97, 49152, v13
    v_add_u32 v98, 49152, v14
    v_add_u32 v99, 49152, v15
    v_add_u32 v100, 49152, v16
    v_add_u32 v101, 49152, v17
    v_add_u32 v102, 49152, v18
    v_add_u32 v103, 49152, v19
    v_add_u32 v104, 73728, v12
    v_add_u32 v105, 73728, v13
    v_add_u32 v106, 73728, v14
    v_add_u32 v107, 73728, v15
    v_add_u32 v108, 73728, v16
    v_add_u32 v109, 73728, v17
    v_add_u32 v110, 73728, v18
    v_add_u32 v111, 73728, v19
    v_add_u32 v112, 98304, v12
    v_add_u32 v113, 98304, v13
    v_add_u32 v114, 98304, v14
    v_add_u32 v115, 98304, v15
    v_add_u32 v116, 98304, v16
    v_add_u32 v117, 98304, v17
    v_add_u32 v118, 98304, v18
    v_add_u32 v119, 98304, v19
    s_mul_i32 s44, s34, 81920
    s_lshl_b32 s45, s35, 8
    s_add_u32 s44, s44, s45
    s_add_u32 s45, s44, 12582912
    v_lshl_add_u32 v7, v5, 5, v3
    v_mul_u32_u24 v7, 1280, v7
    v_lshl_add_u32 v7, v6, 6, v7
    v_lshl_add_u32 v7, v4, 3, v7
    buffer_load_dwordx2 v[20:21], v7, s[8:11], s45 offen offset:0
    buffer_load_dwordx2 v[22:23], v7, s[8:11], s45 offen offset:16
    buffer_load_dwordx2 v[24:25], v7, s[8:11], s45 offen offset:32
    buffer_load_dwordx2 v[26:27], v7, s[8:11], s45 offen offset:48
    s_add_u32 s40, s36, 0
    s_add_u32 m0, s43, 0
    s_nop 0
    buffer_load_dwordx4 v10, s[8:11], s40 offen lds
    s_add_u32 s40, s37, 0
    s_add_u32 m0, s43, 8192
    s_nop 0
    buffer_load_dwordx4 v10, s[8:11], s40 offen lds
    s_add_u32 s40, s38, 0
    s_add_u32 m0, s43, 16384
    s_nop 0
    buffer_load_dwordx4 v10, s[8:11], s40 offen lds
    s_add_u32 s36, s36, 128
    s_add_u32 s37, s37, 128
    s_add_u32 s38, s38, 128
    s_add_u32 s40, s36, 0
    s_add_u32 m0, s43, 24576
    s_nop 0
    buffer_load_dwordx4 v10, s[8:11], s40 offen lds
    s_add_u32 s40, s37, 0
    s_add_u32 m0, s43, 32768
    s_nop 0
    buffer_load_dwordx4 v10, s[8:11], s40 offen lds
    s_add_u32 s40, s38, 0
    s_add_u32 m0, s43, 40960
    s_nop 0
    buffer_load_dwordx4 v10, s[8:11], s40 offen lds
    s_add_u32 s36, s36, 128
    s_add_u32 s37, s37, 128
    s_add_u32 s38, s38, 128
    s_add_u32 s40, s36, 0
    s_add_u32 m0, s43, 49152
    s_nop 0
    buffer_load_dwordx4 v10, s[8:11], s40 offen lds
    s_add_u32 s40, s37, 0
    s_add_u32 m0, s43, 57344
    s_nop 0
    buffer_load_dwordx4 v10, s[8:11], s40 offen lds
    s_add_u32 s40, s38, 0
    s_add_u32 m0, s43, 65536
    s_nop 0
    buffer_load_dwordx4 v10, s[8:11], s40 offen lds
    s_add_u32 s36, s36, 128
    s_add_u32 s37, s37, 128
    s_add_u32 s38, s38, 128
    s_add_u32 s40, s36, 0
    s_add_u32 m0, s43, 73728
    s_nop 0
    buffer_load_dwordx4 v10, s[8:11], s40 offen lds
    s_add_u32 s40, s37, 0
    s_add_u32 m0, s43, 81920
    s_nop 0
    buffer_load_dwordx4 v10, s[8:11], s40 offen lds
    s_add_u32 s40, s38, 0
    s_add_u32 m0, s43, 90112
    s_nop 0
    buffer_load_dwordx4 v10, s[8:11], s40 offen lds
    s_add_u32 s36, s36, 128
    s_add_u32 s37, s37, 128
    s_add_u32 s38, s38, 128
    s_waitcnt vmcnt(9)
    s_barrier
    ds_read_b128 v[128:131], v12 offset:0
    ds_read_b128 v[136:139], v16 offset:0
    ds_read_b128 v[144:147], v13 offset:0
    ds_read_b128 v[152:155], v17 offset:0
    ds_read_b128 v[160:163], v14 offset:0
    ds_read_b128 v[168:171], v18 offset:0
    ds_read_b128 v[176:179], v15 offset:0
    ds_read_b128 v[184:187], v19 offset:0
    s_waitcnt lgkmcnt(6)
    v_mfma_f32_32x32x16_bf16 v[56:71], v[136:139], v[128:131], v[56:71]
    s_add_u32 s40, s36, 0
    s_add_u32 m0, s43, 98304
    s_nop 0
    buffer_load_dwordx4 v10, s[8:11], s40 offen lds
    s_waitcnt lgkmcnt(4)
    v_mfma_f32_32x32x16_bf16 v[56:71], v[152:155], v[144:147], v[56:71]
    s_add_u32 s40, s37, 0
    s_add_u32 m0, s43, 106496
    s_nop 0
    buffer_load_dwordx4 v10, s[8:11], s40 offen lds
    s_waitcnt lgkmcnt(2)
    v_mfma_f32_32x32x16_bf16 v[56:71], v[168:171], v[160:163], v[56:71]
    s_add_u32 s40, s38, 0
    s_add_u32 m0, s43, 114688
    s_nop 0
    buffer_load_dwordx4 v10, s[8:11], s40 offen lds
    s_add_u32 s36, s36, 128
    s_add_u32 s37, s37, 128
    s_add_u32 s38, s38, 128
    s_waitcnt lgkmcnt(0)
    v_mfma_f32_32x32x16_bf16 v[56:71], v[184:187], v[176:179], v[56:71]
    s_waitcnt vmcnt(9)
    s_barrier
    ds_read_b128 v[128:131], v88 offset:0
    ds_read_b128 v[136:139], v92 offset:0
    ds_read_b128 v[144:147], v89 offset:0
    ds_read_b128 v[152:155], v93 offset:0
    ds_read_b128 v[160:163], v90 offset:0
    ds_read_b128 v[168:171], v94 offset:0
    ds_read_b128 v[176:179], v91 offset:0
    ds_read_b128 v[184:187], v95 offset:0
    s_waitcnt lgkmcnt(6)
    v_mfma_f32_32x32x16_bf16 v[56:71], v[136:139], v[128:131], v[56:71]
    s_add_u32 s40, s36, 0
    s_add_u32 m0, s43, 0
    s_nop 0
    buffer_load_dwordx4 v10, s[8:11], s40 offen lds
    s_waitcnt lgkmcnt(4)
    v_mfma_f32_32x32x16_bf16 v[56:71], v[152:155], v[144:147], v[56:71]
    s_add_u32 s40, s37, 0
    s_add_u32 m0, s43, 8192
    s_nop 0
    buffer_load_dwordx4 v10, s[8:11], s40 offen lds
    s_waitcnt lgkmcnt(2)
    v_mfma_f32_32x32x16_bf16 v[56:71], v[168:171], v[160:163], v[56:71]
    s_add_u32 s40, s38, 0
    s_add_u32 m0, s43, 16384
    s_nop 0
    buffer_load_dwordx4 v10, s[8:11], s40 offen lds
    s_add_u32 s36, s36, 128
    s_add_u32 s37, s37, 128
    s_add_u32 s38, s38, 128
    s_waitcnt lgkmcnt(0)
    v_mfma_f32_32x32x16_bf16 v[56:71], v[184:187], v[176:179], v[56:71]
    s_waitcnt vmcnt(9)
    s_barrier
    ds_read_b128 v[128:131], v96 offset:0
    ds_read_b128 v[136:139], v100 offset:0
    ds_read_b128 v[144:147], v97 offset:0
    ds_read_b128 v[152:155], v101 offset:0
    ds_read_b128 v[160:163], v98 offset:0
    ds_read_b128 v[168:171], v102 offset:0
    ds_read_b128 v[176:179], v99 offset:0
    ds_read_b128 v[184:187], v103 offset:0
    s_waitcnt lgkmcnt(6)
    v_mfma_f32_32x32x16_bf16 v[56:71], v[136:139], v[128:131], v[56:71]
    s_add_u32 s40, s36, 0
    s_add_u32 m0, s43, 24576
    s_nop 0
    buffer_load_dwordx4 v10, s[8:11], s40 offen lds
    s_waitcnt lgkmcnt(4)
    v_mfma_f32_32x32x16_bf16 v[56:71], v[152:155], v[144:147], v[56:71]
    s_add_u32 s40, s37, 0
    s_add_u32 m0, s43, 32768
    s_nop 0
    buffer_load_dwordx4 v10, s[8:11], s40 offen lds
    s_waitcnt lgkmcnt(2)
    v_mfma_f32_32x32x16_bf16 v[56:71], v[168:171], v[160:163], v[56:71]
    s_add_u32 s40, s38, 0
    s_add_u32 m0, s43, 40960
    s_nop 0
    buffer_load_dwordx4 v10, s[8:11], s40 offen lds
    s_add_u32 s36, s36, 128
    s_add_u32 s37, s37, 128
    s_add_u32 s38, s38, 128
    s_waitcnt lgkmcnt(0)
    v_mfma_f32_32x32x16_bf16 v[56:71], v[184:187], v[176:179], v[56:71]
    s_waitcnt vmcnt(9)
    s_barrier
    ds_read_b128 v[128:131], v104 offset:0
    ds_read_b128 v[136:139], v108 offset:0
    ds_read_b128 v[144:147], v105 offset:0
    ds_read_b128 v[152:155], v109 offset:0
    ds_read_b128 v[160:163], v106 offset:0
    ds_read_b128 v[168:171], v110 offset:0
    ds_read_b128 v[176:179], v107 offset:0
    ds_read_b128 v[184:187], v111 offset:0
    s_waitcnt lgkmcnt(6)
    v_mfma_f32_32x32x16_bf16 v[56:71], v[136:139], v[128:131], v[56:71]
    s_add_u32 s40, s36, 0
    s_add_u32 m0, s43, 49152
    s_nop 0
    buffer_load_dwordx4 v10, s[8:11], s40 offen lds
    s_waitcnt lgkmcnt(4)
    v_mfma_f32_32x32x16_bf16 v[56:71], v[152:155], v[144:147], v[56:71]
    s_add_u32 s40, s37, 0
    s_add_u32 m0, s43, 57344
    s_nop 0
    buffer_load_dwordx4 v10, s[8:11], s40 offen lds
    s_waitcnt lgkmcnt(2)
    v_mfma_f32_32x32x16_bf16 v[56:71], v[168:171], v[160:163], v[56:71]
    s_add_u32 s40, s38, 0
    s_add_u32 m0, s43, 65536
    s_nop 0
    buffer_load_dwordx4 v10, s[8:11], s40 offen lds
    s_add_u32 s36, s36, 128
    s_add_u32 s37, s37, 128
    s_add_u32 s38, s38, 128
    s_waitcnt lgkmcnt(0)
    v_mfma_f32_32x32x16_bf16 v[56:71], v[184:187], v[176:179], v[56:71]
    s_waitcnt vmcnt(9)
    s_barrier
    ds_read_b128 v[128:131], v112 offset:0
    ds_read_b128 v[136:139], v116 offset:0
    ds_read_b128 v[144:147], v113 offset:0
    ds_read_b128 v[152:155], v117 offset:0
    ds_read_b128 v[160:163], v114 offset:0
    ds_read_b128 v[168:171], v118 offset:0
    ds_read_b128 v[176:179], v115 offset:0
    ds_read_b128 v[184:187], v119 offset:0
    s_waitcnt lgkmcnt(6)
    v_mfma_f32_32x32x16_bf16 v[56:71], v[136:139], v[128:131], v[56:71]
    s_add_u32 s40, s36, 0
    s_add_u32 m0, s43, 73728
    s_nop 0
    buffer_load_dwordx4 v10, s[8:11], s40 offen lds
    s_waitcnt lgkmcnt(4)
    v_mfma_f32_32x32x16_bf16 v[56:71], v[152:155], v[144:147], v[56:71]
    s_add_u32 s40, s37, 0
    s_add_u32 m0, s43, 81920
    s_nop 0
    buffer_load_dwordx4 v10, s[8:11], s40 offen lds
    s_waitcnt lgkmcnt(2)
    v_mfma_f32_32x32x16_bf16 v[56:71], v[168:171], v[160:163], v[56:71]
    s_add_u32 s40, s38, 0
    s_add_u32 m0, s43, 90112
    s_nop 0
    buffer_load_dwordx4 v10, s[8:11], s40 offen lds
    s_add_u32 s36, s36, 128
    s_add_u32 s37, s37, 128
    s_add_u32 s38, s38, 128
    s_waitcnt lgkmcnt(0)
    v_mfma_f32_32x32x16_bf16 v[56:71], v[184:187], v[176:179], v[56:71]
    s_waitcnt vmcnt(9)
    s_barrier
    ds_read_b128 v[128:131], v12 offset:0
    ds_read_b128 v[136:139], v16 offset:0
    ds_read_b128 v[144:147], v13 offset:0
    ds_read_b128 v[152:155], v17 offset:0
    ds_read_b128 v[160:163], v14 offset:0
    ds_read_b128 v[168:171], v18 offset:0
    ds_read_b128 v[176:179], v15 offset:0
    ds_read_b128 v[184:187], v19 offset:0
    s_waitcnt lgkmcnt(6)
    v_mfma_f32_32x32x16_bf16 v[56:71], v[136:139], v[128:131], v[56:71]
    s_add_u32 s40, s36, 0
    s_add_u32 m0, s43, 98304
    s_nop 0
    buffer_load_dwordx4 v10, s[8:11], s40 offen lds
    s_waitcnt lgkmcnt(4)
    v_mfma_f32_32x32x16_bf16 v[56:71], v[152:155], v[144:147], v[56:71]
    s_add_u32 s40, s37, 0
    s_add_u32 m0, s43, 106496
    s_nop 0
    buffer_load_dwordx4 v10, s[8:11], s40 offen lds
    s_waitcnt lgkmcnt(2)
    v_mfma_f32_32x32x16_bf16 v[56:71], v[168:171], v[160:163], v[56:71]
    s_add_u32 s40, s38, 0
    s_add_u32 m0, s43, 114688
    s_nop 0
    buffer_load_dwordx4 v10, s[8:11], s40 offen lds
    s_add_u32 s36, s36, 128
    s_add_u32 s37, s37, 128
    s_add_u32 s38, s38, 128
    s_waitcnt lgkmcnt(0)
    v_mfma_f32_32x32x16_bf16 v[56:71], v[184:187], v[176:179], v[56:71]
    s_waitcnt vmcnt(9)
    s_barrier
    ds_read_b128 v[128:131], v88 offset:0
    ds_read_b128 v[136:139], v92 offset:0
    ds_read_b128 v[144:147], v89 offset:0
    ds_read_b128 v[152:155], v93 offset:0
    ds_read_b128 v[160:163], v90 offset:0
    ds_read_b128 v[168:171], v94 offset:0
    ds_read_b128 v[176:179], v91 offset:0
    ds_read_b128 v[184:187], v95 offset:0
    s_waitcnt lgkmcnt(6)
    v_mfma_f32_32x32x16_bf16 v[56:71], v[136:139], v[128:131], v[56:71]
    s_add_u32 s40, s36, 0
    s_add_u32 m0, s43, 0
    s_nop 0
    buffer_load_dwordx4 v10, s[8:11], s40 offen lds
    s_waitcnt lgkmcnt(4)
    v_mfma_f32_32x32x16_bf16 v[56:71], v[152:155], v[144:147], v[56:71]
    s_add_u32 s40, s37, 0
    s_add_u32 m0, s43, 8192
    s_nop 0
    buffer_load_dwordx4 v10, s[8:11], s40 offen lds
    s_waitcnt lgkmcnt(2)
    v_mfma_f32_32x32x16_bf16 v[56:71], v[168:171], v[160:163], v[56:71]
    s_add_u32 s40, s38, 0
    s_add_u32 m0, s43, 16384
    s_nop 0
    buffer_load_dwordx4 v10, s[8:11], s40 offen lds
    s_add_u32 s36, s36, 128
    s_add_u32 s37, s37, 128
    s_add_u32 s38, s38, 128
    s_waitcnt lgkmcnt(0)
    v_mfma_f32_32x32x16_bf16 v[56:71], v[184:187], v[176:179], v[56:71]
    s_waitcnt vmcnt(9)
    s_barrier
    ds_read_b128 v[128:131], v96 offset:0
    ds_read_b128 v[136:139], v100 offset:0
    ds_read_b128 v[144:147], v97 offset:0
    ds_read_b128 v[152:155], v101 offset:0
    ds_read_b128 v[160:163], v98 offset:0
    ds_read_b128 v[168:171], v102 offset:0
    ds_read_b128 v[176:179], v99 offset:0
    ds_read_b128 v[184:187], v103 offset:0
    s_waitcnt lgkmcnt(6)
    v_mfma_f32_32x32x16_bf16 v[56:71], v[136:139], v[128:131], v[56:71]
    s_add_u32 s40, s36, 0
    s_add_u32 m0, s43, 24576
    s_nop 0
    buffer_load_dwordx4 v10, s[8:11], s40 offen lds
    s_waitcnt lgkmcnt(4)
    v_mfma_f32_32x32x16_bf16 v[56:71], v[152:155], v[144:147], v[56:71]
    s_add_u32 s40, s37, 0
    s_add_u32 m0, s43, 32768
    s_nop 0
    buffer_load_dwordx4 v10, s[8:11], s40 offen lds
    s_waitcnt lgkmcnt(2)
    v_mfma_f32_32x32x16_bf16 v[56:71], v[168:171], v[160:163], v[56:71]
    s_add_u32 s40, s38, 0
    s_add_u32 m0, s43, 40960
    s_nop 0
    buffer_load_dwordx4 v10, s[8:11], s40 offen lds
    s_add_u32 s36, s36, 128
    s_add_u32 s37, s37, 128
    s_add_u32 s38, s38, 128
    s_waitcnt lgkmcnt(0)
    v_mfma_f32_32x32x16_bf16 v[56:71], v[184:187], v[176:179], v[56:71]
    s_waitcnt vmcnt(9)
    s_barrier
    ds_read_b128 v[128:131], v104 offset:0
    ds_read_b128 v[136:139], v108 offset:0
    ds_read_b128 v[144:147], v105 offset:0
    ds_read_b128 v[152:155], v109 offset:0
    ds_read_b128 v[160:163], v106 offset:0
    ds_read_b128 v[168:171], v110 offset:0
    ds_read_b128 v[176:179], v107 offset:0
    ds_read_b128 v[184:187], v111 offset:0
    s_waitcnt lgkmcnt(6)
    v_mfma_f32_32x32x16_bf16 v[56:71], v[136:139], v[128:131], v[56:71]
    s_add_u32 s40, s36, 0
    s_add_u32 m0, s43, 49152
    s_nop 0
    buffer_load_dwordx4 v10, s[8:11], s40 offen lds
    s_waitcnt lgkmcnt(4)
    v_mfma_f32_32x32x16_bf16 v[56:71], v[152:155], v[144:147], v[56:71]
    s_add_u32 s40, s37, 0
    s_add_u32 m0, s43, 57344
    s_nop 0
    buffer_load_dwordx4 v10, s[8:11], s40 offen lds
    s_waitcnt lgkmcnt(2)
    v_mfma_f32_32x32x16_bf16 v[56:71], v[168:171], v[160:163], v[56:71]
    s_add_u32 s40, s38, 0
    s_add_u32 m0, s43, 65536
    s_nop 0
    buffer_load_dwordx4 v10, s[8:11], s40 offen lds
    s_add_u32 s36, s36, 128
    s_add_u32 s37, s37, 128
    s_add_u32 s38, s38, 128
    s_waitcnt lgkmcnt(0)
    v_mfma_f32_32x32x16_bf16 v[56:71], v[184:187], v[176:179], v[56:71]
    s_waitcnt vmcnt(9)
    s_barrier
    ds_read_b128 v[128:131], v112 offset:0
    ds_read_b128 v[136:139], v116 offset:0
    ds_read_b128 v[144:147], v113 offset:0
    ds_read_b128 v[152:155], v117 offset:0
    ds_read_b128 v[160:163], v114 offset:0
    ds_read_b128 v[168:171], v118 offset:0
    ds_read_b128 v[176:179], v115 offset:0
    ds_read_b128 v[184:187], v119 offset:0
    s_waitcnt lgkmcnt(6)
    v_mfma_f32_32x32x16_bf16 v[56:71], v[136:139], v[128:131], v[56:71]
    s_add_u32 s40, s36, 0
    s_add_u32 m0, s43, 73728
    s_nop 0
    buffer_load_dwordx4 v10, s[8:11], s40 offen lds
    s_waitcnt lgkmcnt(4)
    v_mfma_f32_32x32x16_bf16 v[56:71], v[152:155], v[144:147], v[56:71]
    s_add_u32 s40, s37, 0
    s_add_u32 m0, s43, 81920
    s_nop 0
    buffer_load_dwordx4 v10, s[8:11], s40 offen lds
    s_waitcnt lgkmcnt(2)
    v_mfma_f32_32x32x16_bf16 v[56:71], v[168:171], v[160:163], v[56:71]
    s_add_u32 s40, s38, 0
    s_add_u32 m0, s43, 90112
    s_nop 0
    buffer_load_dwordx4 v10, s[8:11], s40 offen lds
    s_add_u32 s36, s36, 128
    s_add_u32 s37, s37, 128
    s_add_u32 s38, s38, 128
    s_waitcnt lgkmcnt(0)
    v_mfma_f32_32x32x16_bf16 v[56:71], v[184:187], v[176:179], v[56:71]
    s_waitcnt vmcnt(9)
    s_barrier
    ds_read_b128 v[128:131], v12 offset:0
    ds_read_b128 v[136:139], v16 offset:0
    ds_read_b128 v[144:147], v13 offset:0
    ds_read_b128 v[152:155], v17 offset:0
    ds_read_b128 v[160:163], v14 offset:0
    ds_read_b128 v[168:171], v18 offset:0
    ds_read_b128 v[176:179], v15 offset:0
    ds_read_b128 v[184:187], v19 offset:0
    s_waitcnt lgkmcnt(6)
    v_mfma_f32_32x32x16_bf16 v[56:71], v[136:139], v[128:131], v[56:71]
    s_add_u32 s40, s36, 0
    s_add_u32 m0, s43, 98304
    s_nop 0
    buffer_load_dwordx4 v10, s[8:11], s40 offen lds
    s_waitcnt lgkmcnt(4)
    v_mfma_f32_32x32x16_bf16 v[56:71], v[152:155], v[144:147], v[56:71]
    s_add_u32 s40, s37, 0
    s_add_u32 m0, s43, 106496
    s_nop 0
    buffer_load_dwordx4 v10, s[8:11], s40 offen lds
    s_waitcnt lgkmcnt(2)
    v_mfma_f32_32x32x16_bf16 v[56:71], v[168:171], v[160:163], v[56:71]
    s_add_u32 s40, s38, 0
    s_add_u32 m0, s43, 114688
    s_nop 0
    buffer_load_dwordx4 v10, s[8:11], s40 offen lds
    s_add_u32 s36, s36, 128
    s_add_u32 s37, s37, 128
    s_add_u32 s38, s38, 128
    s_waitcnt lgkmcnt(0)
    v_mfma_f32_32x32x16_bf16 v[56:71], v[184:187], v[176:179], v[56:71]
    s_waitcnt vmcnt(9)
    s_barrier
    ds_read_b128 v[128:131], v88 offset:0
    ds_read_b128 v[136:139], v92 offset:0
    ds_read_b128 v[144:147], v89 offset:0
    ds_read_b128 v[152:155], v93 offset:0
    ds_read_b128 v[160:163], v90 offset:0
    ds_read_b128 v[168:171], v94 offset:0
    ds_read_b128 v[176:179], v91 offset:0
    ds_read_b128 v[184:187], v95 offset:0
    s_waitcnt lgkmcnt(6)
    v_mfma_f32_32x32x16_bf16 v[56:71], v[136:139], v[128:131], v[56:71]
    s_add_u32 s40, s36, 0
    s_add_u32 m0, s43, 0
    s_nop 0
    buffer_load_dwordx4 v10, s[8:11], s40 offen lds
    s_waitcnt lgkmcnt(4)
    v_mfma_f32_32x32x16_bf16 v[56:71], v[152:155], v[144:147], v[56:71]
    s_add_u32 s40, s37, 0
    s_add_u32 m0, s43, 8192
    s_nop 0
    buffer_load_dwordx4 v10, s[8:11], s40 offen lds
    s_waitcnt lgkmcnt(2)
    v_mfma_f32_32x32x16_bf16 v[56:71], v[168:171], v[160:163], v[56:71]
    s_add_u32 s40, s38, 0
    s_add_u32 m0, s43, 16384
    s_nop 0
    buffer_load_dwordx4 v10, s[8:11], s40 offen lds
    s_add_u32 s36, s36, 128
    s_add_u32 s37, s37, 128
    s_add_u32 s38, s38, 128
    s_waitcnt lgkmcnt(0)
    v_mfma_f32_32x32x16_bf16 v[56:71], v[184:187], v[176:179], v[56:71]
    s_waitcnt vmcnt(9)
    s_barrier
    ds_read_b128 v[128:131], v96 offset:0
    ds_read_b128 v[136:139], v100 offset:0
    ds_read_b128 v[144:147], v97 offset:0
    ds_read_b128 v[152:155], v101 offset:0
    ds_read_b128 v[160:163], v98 offset:0
    ds_read_b128 v[168:171], v102 offset:0
    ds_read_b128 v[176:179], v99 offset:0
    ds_read_b128 v[184:187], v103 offset:0
    s_waitcnt lgkmcnt(6)
    v_mfma_f32_32x32x16_bf16 v[56:71], v[136:139], v[128:131], v[56:71]
    s_add_u32 s40, s36, 0
    s_add_u32 m0, s43, 24576
    s_nop 0
    buffer_load_dwordx4 v10, s[8:11], s40 offen lds
    s_waitcnt lgkmcnt(4)
    v_mfma_f32_32x32x16_bf16 v[56:71], v[152:155], v[144:147], v[56:71]
    s_add_u32 s40, s37, 0
    s_add_u32 m0, s43, 32768
    s_nop 0
    buffer_load_dwordx4 v10, s[8:11], s40 offen lds
    s_waitcnt lgkmcnt(2)
    v_mfma_f32_32x32x16_bf16 v[56:71], v[168:171], v[160:163], v[56:71]
    s_add_u32 s40, s38, 0
    s_add_u32 m0, s43, 40960
    s_nop 0
    buffer_load_dwordx4 v10, s[8:11], s40 offen lds
    s_add_u32 s36, s36, 128
    s_add_u32 s37, s37, 128
    s_add_u32 s38, s38, 128
    s_waitcnt lgkmcnt(0)
    v_mfma_f32_32x32x16_bf16 v[56:71], v[184:187], v[176:179], v[56:71]
    s_waitcnt vmcnt(9)
    s_barrier
    ds_read_b128 v[128:131], v104 offset:0
    ds_read_b128 v[136:139], v108 offset:0
    ds_read_b128 v[144:147], v105 offset:0
    ds_read_b128 v[152:155], v109 offset:0
    ds_read_b128 v[160:163], v106 offset:0
    ds_read_b128 v[168:171], v110 offset:0
    ds_read_b128 v[176:179], v107 offset:0
    ds_read_b128 v[184:187], v111 offset:0
    s_waitcnt lgkmcnt(6)
    v_mfma_f32_32x32x16_bf16 v[56:71], v[136:139], v[128:131], v[56:71]
    s_add_u32 s40, s36, 0
    s_add_u32 m0, s43, 49152
    s_nop 0
    buffer_load_dwordx4 v10, s[8:11], s40 offen lds
    s_waitcnt lgkmcnt(4)
    v_mfma_f32_32x32x16_bf16 v[56:71], v[152:155], v[144:147], v[56:71]
    s_add_u32 s40, s37, 0
    s_add_u32 m0, s43, 57344
    s_nop 0
    buffer_load_dwordx4 v10, s[8:11], s40 offen lds
    s_waitcnt lgkmcnt(2)
    v_mfma_f32_32x32x16_bf16 v[56:71], v[168:171], v[160:163], v[56:71]
    s_add_u32 s40, s38, 0
    s_add_u32 m0, s43, 65536
    s_nop 0
    buffer_load_dwordx4 v10, s[8:11], s40 offen lds
    s_add_u32 s36, s36, 128
    s_add_u32 s37, s37, 128
    s_add_u32 s38, s38, 128
    s_waitcnt lgkmcnt(0)
    v_mfma_f32_32x32x16_bf16 v[56:71], v[184:187], v[176:179], v[56:71]
    s_waitcnt vmcnt(9)
    s_barrier
    ds_read_b128 v[128:131], v112 offset:0
    ds_read_b128 v[136:139], v116 offset:0
    ds_read_b128 v[144:147], v113 offset:0
    ds_read_b128 v[152:155], v117 offset:0
    ds_read_b128 v[160:163], v114 offset:0
    ds_read_b128 v[168:171], v118 offset:0
    ds_read_b128 v[176:179], v115 offset:0
    ds_read_b128 v[184:187], v119 offset:0
    s_waitcnt lgkmcnt(6)
    v_mfma_f32_32x32x16_bf16 v[56:71], v[136:139], v[128:131], v[56:71]
    s_add_u32 s40, s36, 0
    s_add_u32 m0, s43, 73728
    s_nop 0
    buffer_load_dwordx4 v10, s[8:11], s40 offen lds
    s_waitcnt lgkmcnt(4)
    v_mfma_f32_32x32x16_bf16 v[56:71], v[152:155], v[144:147], v[56:71]
    s_add_u32 s40, s37, 0
    s_add_u32 m0, s43, 81920
    s_nop 0
    buffer_load_dwordx4 v10, s[8:11], s40 offen lds
    s_waitcnt lgkmcnt(2)
    v_mfma_f32_32x32x16_bf16 v[56:71], v[168:171], v[160:163], v[56:71]
    s_add_u32 s40, s38, 0
    s_add_u32 m0, s43, 90112
    s_nop 0
    buffer_load_dwordx4 v10, s[8:11], s40 offen lds
    s_add_u32 s36, s36, 128
    s_add_u32 s37, s37, 128
    s_add_u32 s38, s38, 128
    s_waitcnt lgkmcnt(0)
    v_mfma_f32_32x32x16_bf16 v[56:71], v[184:187], v[176:179], v[56:71]
    s_waitcnt vmcnt(9)
    s_barrier
    ds_read_b128 v[128:131], v12 offset:0
    ds_read_b128 v[136:139], v16 offset:0
    ds_read_b128 v[144:147], v13 offset:0
    ds_read_b128 v[152:155], v17 offset:0
    ds_read_b128 v[160:163], v14 offset:0
    ds_read_b128 v[168:171], v18 offset:0
    ds_read_b128 v[176:179], v15 offset:0
    ds_read_b128 v[184:187], v19 offset:0
    s_waitcnt lgkmcnt(6)
    v_mfma_f32_32x32x16_bf16 v[56:71], v[136:139], v[128:131], v[56:71]
    s_add_u32 s40, s36, 0
    s_add_u32 m0, s43, 98304
    s_nop 0
    buffer_load_dwordx4 v10, s[8:11], s40 offen lds
    s_waitcnt lgkmcnt(4)
    v_mfma_f32_32x32x16_bf16 v[56:71], v[152:155], v[144:147], v[56:71]
    s_add_u32 s40, s37, 0
    s_add_u32 m0, s43, 106496
    s_nop 0
    buffer_load_dwordx4 v10, s[8:11], s40 offen lds
    s_waitcnt lgkmcnt(2)
    v_mfma_f32_32x32x16_bf16 v[56:71], v[168:171], v[160:163], v[56:71]
    s_add_u32 s40, s38, 0
    s_add_u32 m0, s43, 114688
    s_nop 0
    buffer_load_dwordx4 v10, s[8:11], s40 offen lds
    s_add_u32 s36, s36, 128
    s_add_u32 s37, s37, 128
    s_add_u32 s38, s38, 128
    s_waitcnt lgkmcnt(0)
    v_mfma_f32_32x32x16_bf16 v[56:71], v[184:187], v[176:179], v[56:71]
    s_waitcnt vmcnt(9)
    s_barrier
    ds_read_b128 v[128:131], v88 offset:0
    ds_read_b128 v[136:139], v92 offset:0
    ds_read_b128 v[144:147], v89 offset:0
    ds_read_b128 v[152:155], v93 offset:0
    ds_read_b128 v[160:163], v90 offset:0
    ds_read_b128 v[168:171], v94 offset:0
    ds_read_b128 v[176:179], v91 offset:0
    ds_read_b128 v[184:187], v95 offset:0
    s_waitcnt lgkmcnt(6)
    v_mfma_f32_32x32x16_bf16 v[56:71], v[136:139], v[128:131], v[56:71]
    s_add_u32 s40, s36, 0
    s_add_u32 m0, s43, 0
    s_nop 0
    buffer_load_dwordx4 v10, s[8:11], s40 offen lds
    s_waitcnt lgkmcnt(4)
    v_mfma_f32_32x32x16_bf16 v[56:71], v[152:155], v[144:147], v[56:71]
    s_add_u32 s40, s37, 0
    s_add_u32 m0, s43, 8192
    s_nop 0
    buffer_load_dwordx4 v10, s[8:11], s40 offen lds
    s_waitcnt lgkmcnt(2)
    v_mfma_f32_32x32x16_bf16 v[56:71], v[168:171], v[160:163], v[56:71]
    s_add_u32 s40, s38, 0
    s_add_u32 m0, s43, 16384
    s_nop 0
    buffer_load_dwordx4 v10, s[8:11], s40 offen lds
    s_add_u32 s36, s36, 128
    s_add_u32 s37, s37, 128
    s_add_u32 s38, s38, 128
    s_waitcnt lgkmcnt(0)
    v_mfma_f32_32x32x16_bf16 v[56:71], v[184:187], v[176:179], v[56:71]
    s_waitcnt vmcnt(9)
    s_barrier
    ds_read_b128 v[128:131], v96 offset:0
    ds_read_b128 v[136:139], v100 offset:0
    ds_read_b128 v[144:147], v97 offset:0
    ds_read_b128 v[152:155], v101 offset:0
    ds_read_b128 v[160:163], v98 offset:0
    ds_read_b128 v[168:171], v102 offset:0
    ds_read_b128 v[176:179], v99 offset:0
    ds_read_b128 v[184:187], v103 offset:0
    s_waitcnt lgkmcnt(6)
    v_mfma_f32_32x32x16_bf16 v[56:71], v[136:139], v[128:131], v[56:71]
    s_add_u32 s40, s36, 0
    s_add_u32 m0, s43, 24576
    s_nop 0
    buffer_load_dwordx4 v10, s[8:11], s40 offen lds
    s_waitcnt lgkmcnt(4)
    v_mfma_f32_32x32x16_bf16 v[56:71], v[152:155], v[144:147], v[56:71]
    s_add_u32 s40, s37, 0
    s_add_u32 m0, s43, 32768
    s_nop 0
    buffer_load_dwordx4 v10, s[8:11], s40 offen lds
    s_waitcnt lgkmcnt(2)
    v_mfma_f32_32x32x16_bf16 v[56:71], v[168:171], v[160:163], v[56:71]
    s_add_u32 s40, s38, 0
    s_add_u32 m0, s43, 40960
    s_nop 0
    buffer_load_dwordx4 v10, s[8:11], s40 offen lds
    s_add_u32 s36, s36, 128
    s_add_u32 s37, s37, 128
    s_add_u32 s38, s38, 128
    s_waitcnt lgkmcnt(0)
    v_mfma_f32_32x32x16_bf16 v[56:71], v[184:187], v[176:179], v[56:71]
    s_waitcnt vmcnt(9)
    s_barrier
    ds_read_b128 v[128:131], v104 offset:0
    ds_read_b128 v[136:139], v108 offset:0
    ds_read_b128 v[144:147], v105 offset:0
    ds_read_b128 v[152:155], v109 offset:0
    ds_read_b128 v[160:163], v106 offset:0
    ds_read_b128 v[168:171], v110 offset:0
    ds_read_b128 v[176:179], v107 offset:0
    ds_read_b128 v[184:187], v111 offset:0
    s_waitcnt lgkmcnt(6)
    v_mfma_f32_32x32x16_bf16 v[56:71], v[136:139], v[128:131], v[56:71]
    s_add_u32 s40, s36, 0
    s_add_u32 m0, s43, 49152
    s_nop 0
    buffer_load_dwordx4 v10, s[8:11], s40 offen lds
    s_waitcnt lgkmcnt(4)
    v_mfma_f32_32x32x16_bf16 v[56:71], v[152:155], v[144:147], v[56:71]
    s_add_u32 s40, s37, 0
    s_add_u32 m0, s43, 57344
    s_nop 0
    buffer_load_dwordx4 v10, s[8:11], s40 offen lds
    s_waitcnt lgkmcnt(2)
    v_mfma_f32_32x32x16_bf16 v[56:71], v[168:171], v[160:163], v[56:71]
    s_add_u32 s40, s38, 0
    s_add_u32 m0, s43, 65536
    s_nop 0
    buffer_load_dwordx4 v10, s[8:11], s40 offen lds
    s_add_u32 s36, s36, 128
    s_add_u32 s37, s37, 128
    s_add_u32 s38, s38, 128
    s_waitcnt lgkmcnt(0)
    v_mfma_f32_32x32x16_bf16 v[56:71], v[184:187], v[176:179], v[56:71]
    s_waitcnt vmcnt(9)
    s_barrier
    ds_read_b128 v[128:131], v112 offset:0
    ds_read_b128 v[136:139], v116 offset:0
    ds_read_b128 v[144:147], v113 offset:0
    ds_read_b128 v[152:155], v117 offset:0
    ds_read_b128 v[160:163], v114 offset:0
    ds_read_b128 v[168:171], v118 offset:0
    ds_read_b128 v[176:179], v115 offset:0
    ds_read_b128 v[184:187], v119 offset:0
    s_waitcnt lgkmcnt(6)
    v_mfma_f32_32x32x16_bf16 v[56:71], v[136:139], v[128:131], v[56:71]
    s_add_u32 s40, s36, 0
    s_add_u32 m0, s43, 73728
    s_nop 0
    buffer_load_dwordx4 v10, s[8:11], s40 offen lds
    s_waitcnt lgkmcnt(4)
    v_mfma_f32_32x32x16_bf16 v[56:71], v[152:155], v[144:147], v[56:71]
    s_add_u32 s40, s37, 0
    s_add_u32 m0, s43, 81920
    s_nop 0
    buffer_load_dwordx4 v10, s[8:11], s40 offen lds
    s_waitcnt lgkmcnt(2)
    v_mfma_f32_32x32x16_bf16 v[56:71], v[168:171], v[160:163], v[56:71]
    s_add_u32 s40, s38, 0
    s_add_u32 m0, s43, 90112
    s_nop 0
    buffer_load_dwordx4 v10, s[8:11], s40 offen lds
    s_add_u32 s36, s36, 128
    s_add_u32 s37, s37, 128
    s_add_u32 s38, s38, 128
    s_waitcnt lgkmcnt(0)
    v_mfma_f32_32x32x16_bf16 v[56:71], v[184:187], v[176:179], v[56:71]
    s_waitcnt vmcnt(9)
    s_barrier
    ds_read_b128 v[128:131], v12 offset:0
    ds_read_b128 v[136:139], v16 offset:0
    ds_read_b128 v[144:147], v13 offset:0
    ds_read_b128 v[152:155], v17 offset:0
    ds_read_b128 v[160:163], v14 offset:0
    ds_read_b128 v[168:171], v18 offset:0
    ds_read_b128 v[176:179], v15 offset:0
    ds_read_b128 v[184:187], v19 offset:0
    s_waitcnt lgkmcnt(6)
    v_mfma_f32_32x32x16_bf16 v[56:71], v[136:139], v[128:131], v[56:71]
    s_add_u32 s40, s36, 0
    s_add_u32 m0, s43, 98304
    s_nop 0
    buffer_load_dwordx4 v10, s[8:11], s40 offen lds
    s_waitcnt lgkmcnt(4)
    v_mfma_f32_32x32x16_bf16 v[56:71], v[152:155], v[144:147], v[56:71]
    s_add_u32 s40, s37, 0
    s_add_u32 m0, s43, 106496
    s_nop 0
    buffer_load_dwordx4 v10, s[8:11], s40 offen lds
    s_waitcnt lgkmcnt(2)
    v_mfma_f32_32x32x16_bf16 v[56:71], v[168:171], v[160:163], v[56:71]
    s_add_u32 s40, s38, 0
    s_add_u32 m0, s43, 114688
    s_nop 0
    buffer_load_dwordx4 v10, s[8:11], s40 offen lds
    s_add_u32 s36, s36, 128
    s_add_u32 s37, s37, 128
    s_add_u32 s38, s38, 128
    s_waitcnt lgkmcnt(0)
    v_mfma_f32_32x32x16_bf16 v[56:71], v[184:187], v[176:179], v[56:71]
    s_waitcnt vmcnt(9)
    s_barrier
    ds_read_b128 v[128:131], v88 offset:0
    ds_read_b128 v[136:139], v92 offset:0
    ds_read_b128 v[144:147], v89 offset:0
    ds_read_b128 v[152:155], v93 offset:0
    ds_read_b128 v[160:163], v90 offset:0
    ds_read_b128 v[168:171], v94 offset:0
    ds_read_b128 v[176:179], v91 offset:0
    ds_read_b128 v[184:187], v95 offset:0
    s_waitcnt lgkmcnt(6)
    v_mfma_f32_32x32x16_bf16 v[56:71], v[136:139], v[128:131], v[56:71]
    s_add_u32 s40, s36, 0
    s_add_u32 m0, s43, 0
    s_nop 0
    buffer_load_dwordx4 v10, s[8:11], s40 offen lds
    s_waitcnt lgkmcnt(4)
    v_mfma_f32_32x32x16_bf16 v[56:71], v[152:155], v[144:147], v[56:71]
    s_add_u32 s40, s37, 0
    s_add_u32 m0, s43, 8192
    s_nop 0
    buffer_load_dwordx4 v10, s[8:11], s40 offen lds
    s_waitcnt lgkmcnt(2)
    v_mfma_f32_32x32x16_bf16 v[56:71], v[168:171], v[160:163], v[56:71]
    s_add_u32 s40, s38, 0
    s_add_u32 m0, s43, 16384
    s_nop 0
    buffer_load_dwordx4 v10, s[8:11], s40 offen lds
    s_add_u32 s36, s36, 128
    s_add_u32 s37, s37, 128
    s_add_u32 s38, s38, 128
    s_waitcnt lgkmcnt(0)
    v_mfma_f32_32x32x16_bf16 v[56:71], v[184:187], v[176:179], v[56:71]
    s_waitcnt vmcnt(9)
    s_barrier
    ds_read_b128 v[128:131], v96 offset:0
    ds_read_b128 v[136:139], v100 offset:0
    ds_read_b128 v[144:147], v97 offset:0
    ds_read_b128 v[152:155], v101 offset:0
    ds_read_b128 v[160:163], v98 offset:0
    ds_read_b128 v[168:171], v102 offset:0
    ds_read_b128 v[176:179], v99 offset:0
    ds_read_b128 v[184:187], v103 offset:0
    s_waitcnt lgkmcnt(6)
    v_mfma_f32_32x32x16_bf16 v[56:71], v[136:139], v[128:131], v[56:71]
    s_add_u32 s40, s36, 0
    s_add_u32 m0, s43, 24576
    s_nop 0
    buffer_load_dwordx4 v10, s[8:11], s40 offen lds
    s_waitcnt lgkmcnt(4)
    v_mfma_f32_32x32x16_bf16 v[56:71], v[152:155], v[144:147], v[56:71]
    s_add_u32 s40, s37, 0
    s_add_u32 m0, s43, 32768
    s_nop 0
    buffer_load_dwordx4 v10, s[8:11], s40 offen lds
    s_waitcnt lgkmcnt(2)
    v_mfma_f32_32x32x16_bf16 v[56:71], v[168:171], v[160:163], v[56:71]
    s_add_u32 s40, s38, 0
    s_add_u32 m0, s43, 40960
    s_nop 0
    buffer_load_dwordx4 v10, s[8:11], s40 offen lds
    s_add_u32 s36, s36, 128
    s_add_u32 s37, s37, 128
    s_add_u32 s38, s38, 128
    s_waitcnt lgkmcnt(0)
    v_mfma_f32_32x32x16_bf16 v[56:71], v[184:187], v[176:179], v[56:71]
    s_waitcnt vmcnt(9)
    s_barrier
    ds_read_b128 v[128:131], v104 offset:0
    ds_read_b128 v[136:139], v108 offset:0
    ds_read_b128 v[144:147], v105 offset:0
    ds_read_b128 v[152:155], v109 offset:0
    ds_read_b128 v[160:163], v106 offset:0
    ds_read_b128 v[168:171], v110 offset:0
    ds_read_b128 v[176:179], v107 offset:0
    ds_read_b128 v[184:187], v111 offset:0
    s_waitcnt lgkmcnt(6)
    v_mfma_f32_32x32x16_bf16 v[56:71], v[136:139], v[128:131], v[56:71]
    s_waitcnt lgkmcnt(4)
    v_mfma_f32_32x32x16_bf16 v[56:71], v[152:155], v[144:147], v[56:71]
    s_waitcnt lgkmcnt(2)
    v_mfma_f32_32x32x16_bf16 v[56:71], v[168:171], v[160:163], v[56:71]
    s_waitcnt lgkmcnt(0)
    v_mfma_f32_32x32x16_bf16 v[56:71], v[184:187], v[176:179], v[56:71]
    s_waitcnt vmcnt(6)
    s_barrier
    ds_read_b128 v[128:131], v112 offset:0
    ds_read_b128 v[136:139], v116 offset:0
    ds_read_b128 v[144:147], v113 offset:0
    ds_read_b128 v[152:155], v117 offset:0
    ds_read_b128 v[160:163], v114 offset:0
    ds_read_b128 v[168:171], v118 offset:0
    ds_read_b128 v[176:179], v115 offset:0
    ds_read_b128 v[184:187], v119 offset:0
    s_waitcnt lgkmcnt(6)
    v_mfma_f32_32x32x16_bf16 v[56:71], v[136:139], v[128:131], v[56:71]
    s_waitcnt lgkmcnt(4)
    v_mfma_f32_32x32x16_bf16 v[56:71], v[152:155], v[144:147], v[56:71]
    s_waitcnt lgkmcnt(2)
    v_mfma_f32_32x32x16_bf16 v[56:71], v[168:171], v[160:163], v[56:71]
    s_waitcnt lgkmcnt(0)
    v_mfma_f32_32x32x16_bf16 v[56:71], v[184:187], v[176:179], v[56:71]
    s_waitcnt vmcnt(3)
    s_barrier
    ds_read_b128 v[128:131], v12 offset:0
    ds_read_b128 v[136:139], v16 offset:0
    ds_read_b128 v[144:147], v13 offset:0
    ds_read_b128 v[152:155], v17 offset:0
    ds_read_b128 v[160:163], v14 offset:0
    ds_read_b128 v[168:171], v18 offset:0
    ds_read_b128 v[176:179], v15 offset:0
    ds_read_b128 v[184:187], v19 offset:0
    s_waitcnt lgkmcnt(6)
    v_mfma_f32_32x32x16_bf16 v[56:71], v[136:139], v[128:131], v[56:71]
    s_waitcnt lgkmcnt(4)
    v_mfma_f32_32x32x16_bf16 v[56:71], v[152:155], v[144:147], v[56:71]
    s_waitcnt lgkmcnt(2)
    v_mfma_f32_32x32x16_bf16 v[56:71], v[168:171], v[160:163], v[56:71]
    s_waitcnt lgkmcnt(0)
    v_mfma_f32_32x32x16_bf16 v[56:71], v[184:187], v[176:179], v[56:71]
    s_waitcnt vmcnt(0)
    s_barrier
    ds_read_b128 v[128:131], v88 offset:0
    ds_read_b128 v[136:139], v92 offset:0
    ds_read_b128 v[144:147], v89 offset:0
    ds_read_b128 v[152:155], v93 offset:0
    ds_read_b128 v[160:163], v90 offset:0
    ds_read_b128 v[168:171], v94 offset:0
    ds_read_b128 v[176:179], v91 offset:0
    ds_read_b128 v[184:187], v95 offset:0
    s_waitcnt lgkmcnt(6)
    v_mfma_f32_32x32x16_bf16 v[56:71], v[136:139], v[128:131], v[56:71]
    s_waitcnt lgkmcnt(4)
    v_mfma_f32_32x32x16_bf16 v[56:71], v[152:155], v[144:147], v[56:71]
    s_waitcnt lgkmcnt(2)
    v_mfma_f32_32x32x16_bf16 v[56:71], v[168:171], v[160:163], v[56:71]
    s_waitcnt lgkmcnt(0)
    v_mfma_f32_32x32x16_bf16 v[56:71], v[184:187], v[176:179], v[56:71]
    s_nop 15
    s_nop 3
    s_mov_b32 s36, s44
    s_waitcnt vmcnt(0)
    v_cvt_pk_bf16_f32 v56, v56, v56
    v_lshlrev_b32 v56, 16, v56
    v_lshlrev_b32 v40, 16, v20
    v_add_f32 v56, v56, v40
    v_cvt_pk_bf16_f32 v57, v57, v57
    v_lshlrev_b32 v57, 16, v57
    v_and_b32 v40, 0xffff0000, v20
    v_add_f32 v57, v57, v40
    v_cvt_pk_bf16_f32 v58, v58, v58
    v_lshlrev_b32 v58, 16, v58
    v_lshlrev_b32 v40, 16, v21
    v_add_f32 v58, v58, v40
    v_cvt_pk_bf16_f32 v59, v59, v59
    v_lshlrev_b32 v59, 16, v59
    v_and_b32 v40, 0xffff0000, v21
    v_add_f32 v59, v59, v40
    v_cvt_pk_bf16_f32 v56, v56, v57
    v_cvt_pk_bf16_f32 v57, v58, v59
    buffer_store_dwordx2 v[56:57], v7, s[28:31], s36 offen offset:0
    v_cvt_pk_bf16_f32 v60, v60, v60
    v_lshlrev_b32 v60, 16, v60
    v_lshlrev_b32 v40, 16, v22
    v_add_f32 v60, v60, v40
    v_cvt_pk_bf16_f32 v61, v61, v61
    v_lshlrev_b32 v61, 16, v61
    v_and_b32 v40, 0xffff0000, v22
    v_add_f32 v61, v61, v40
    v_cvt_pk_bf16_f32 v62, v62, v62
    v_lshlrev_b32 v62, 16, v62
    v_lshlrev_b32 v40, 16, v23
    v_add_f32 v62, v62, v40
    v_cvt_pk_bf16_f32 v63, v63, v63
    v_lshlrev_b32 v63, 16, v63
    v_and_b32 v40, 0xffff0000, v23
    v_add_f32 v63, v63, v40
    v_cvt_pk_bf16_f32 v60, v60, v61
    v_cvt_pk_bf16_f32 v61, v62, v63
    buffer_store_dwordx2 v[60:61], v7, s[28:31], s36 offen offset:16
    v_cvt_pk_bf16_f32 v64, v64, v64
    v_lshlrev_b32 v64, 16, v64
    v_lshlrev_b32 v40, 16, v24
    v_add_f32 v64, v64, v40
    v_cvt_pk_bf16_f32 v65, v65, v65
    v_lshlrev_b32 v65, 16, v65
    v_and_b32 v40, 0xffff0000, v24
    v_add_f32 v65, v65, v40
    v_cvt_pk_bf16_f32 v66, v66, v66
    v_lshlrev_b32 v66, 16, v66
    v_lshlrev_b32 v40, 16, v25
    v_add_f32 v66, v66, v40
    v_cvt_pk_bf16_f32 v67, v67, v67
    v_lshlrev_b32 v67, 16, v67
    v_and_b32 v40, 0xffff0000, v25
    v_add_f32 v67, v67, v40
    v_cvt_pk_bf16_f32 v64, v64, v65
    v_cvt_pk_bf16_f32 v65, v66, v67
    buffer_store_dwordx2 v[64:65], v7, s[28:31], s36 offen offset:32
    v_cvt_pk_bf16_f32 v68, v68, v68
    v_lshlrev_b32 v68, 16, v68
    v_lshlrev_b32 v40, 16, v26
    v_add_f32 v68, v68, v40
    v_cvt_pk_bf16_f32 v69, v69, v69
    v_lshlrev_b32 v69, 16, v69
    v_and_b32 v40, 0xffff0000, v26
    v_add_f32 v69, v69, v40
    v_cvt_pk_bf16_f32 v70, v70, v70
    v_lshlrev_b32 v70, 16, v70
    v_lshlrev_b32 v40, 16, v27
    v_add_f32 v70, v70, v40
    v_cvt_pk_bf16_f32 v71, v71, v71
    v_lshlrev_b32 v71, 16, v71
    v_and_b32 v40, 0xffff0000, v27
    v_add_f32 v71, v71, v40
    v_cvt_pk_bf16_f32 v68, v68, v69
    v_cvt_pk_bf16_f32 v69, v70, v71
    buffer_store_dwordx2 v[68:69], v7, s[28:31], s36 offen offset:48
gemm2_kernel_end:
    s_endpgm
.section .rodata,"a"
.p2align 6
.amdhsa_kernel ln1_kernel
  .amdhsa_next_free_vgpr 128
  .amdhsa_next_free_sgpr 102
  .amdhsa_accum_offset 128
  .amdhsa_group_segment_fixed_size 0
  .amdhsa_kernarg_size 112
  .amdhsa_user_sgpr_count 2
  .amdhsa_user_sgpr_kernarg_segment_ptr 1
  .amdhsa_system_sgpr_workgroup_id_x 1
.end_amdhsa_kernel
.p2align 6
.amdhsa_kernel conv_kernel
  .amdhsa_next_free_vgpr 144
  .amdhsa_next_free_sgpr 102
  .amdhsa_accum_offset 144
  .amdhsa_group_segment_fixed_size 0
  .amdhsa_kernarg_size 112
  .amdhsa_user_sgpr_count 2
  .amdhsa_user_sgpr_kernarg_segment_ptr 1
  .amdhsa_system_sgpr_workgroup_id_x 1
.end_amdhsa_kernel
.p2align 6
.amdhsa_kernel ln2_kernel
  .amdhsa_next_free_vgpr 188
  .amdhsa_next_free_sgpr 102
  .amdhsa_accum_offset 188
  .amdhsa_group_segment_fixed_size 0
  .amdhsa_kernarg_size 112
  .amdhsa_user_sgpr_count 2
  .amdhsa_user_sgpr_kernarg_segment_ptr 1
  .amdhsa_system_sgpr_workgroup_id_x 1
.end_amdhsa_kernel
.p2align 6
.amdhsa_kernel gemm1_kernel
  .amdhsa_next_free_vgpr 208
  .amdhsa_next_free_sgpr 102
  .amdhsa_accum_offset 208
  .amdhsa_group_segment_fixed_size 0
  .amdhsa_kernarg_size 112
  .amdhsa_user_sgpr_count 2
  .amdhsa_user_sgpr_kernarg_segment_ptr 1
  .amdhsa_system_sgpr_workgroup_id_x 1
.end_amdhsa_kernel
.p2align 6
.amdhsa_kernel gemm2_kernel
  .amdhsa_next_free_vgpr 192
  .amdhsa_next_free_sgpr 102
  .amdhsa_accum_offset 192
  .amdhsa_group_segment_fixed_size 0
  .amdhsa_kernarg_size 112
  .amdhsa_user_sgpr_count 2
  .amdhsa_user_sgpr_kernarg_segment_ptr 1
  .amdhsa_system_sgpr_workgroup_id_x 1
.end_amdhsa_kernel
```
